```python
import torch

def _softmax(x, axis=-1):
    return torch.softmax(x, dim=axis)
def _gelu(x):
    return torch.nn.functional.gelu(x, approximate="tanh")
def _silu(x):
    return torch.nn.functional.silu(x)
def _sigmoid(x):
    return torch.sigmoid(x)
def _layernorm(x, axis=-1, eps=1e-5):
    m = x.mean(dim=axis, keepdim=True)
    v = x.var(dim=axis, keepdim=True, unbiased=False)
    return (x - m) / torch.sqrt(v + eps)
def _scatter_add(tgt, idx, src, axis=0):
    return tgt.clone().index_add_(axis, idx, src)
def _segment_sum(src, seg, n):
    out = torch.zeros((n,) + src.shape[1:], dtype=src.dtype)
    return out.index_add_(0, seg, src)
def _pad(x, pw):
    flat = tuple(v for pair in reversed(pw) for v in pair)
    return torch.nn.functional.pad(x, flat)

kernel_name = 'concat_heads__linear_kernel_hedgehog__softmax_full_mha__prompt'

def setup_inputs():

    _w = (lambda a: (lambda t: t.to(torch.bfloat16) if t.is_floating_point() else t)(torch.as_tensor(a)))
    def _A_setup():
        B, S, D, H = 1, 2048, 576, 32
        Dh = D // H
        return {
            "x": _w((lambda *s: torch.randn(*s, dtype=torch.bfloat16) * 0.4)(B, S, D)),
            "wqkv": _w((lambda *s: torch.randn(*s, dtype=torch.bfloat16) * 0.4)(D, 3 * D)),
            "w_phi": _w((lambda *s: torch.randn(*s, dtype=torch.bfloat16) * 0.4)(H, Dh, Dh) * (Dh ** -0.5)),
            "wo": _w((lambda *s: torch.randn(*s, dtype=torch.bfloat16) * 0.05)(D, D)),
        }
    _A_in = _A_setup()

    def _B_setup():
        B, S, D = 1, 2048, 576
        return {
            "x": _w((lambda *s: torch.randn(*s, dtype=torch.bfloat16) * 0.2)(B, S, D)),
            "wqkv": _w((lambda *s: torch.randn(*s, dtype=torch.bfloat16) * 0.2)(D, 3 * D)),
            "wo": _w((lambda *s: torch.randn(*s, dtype=torch.bfloat16) * 0.05)(D, D)),
        }
    _B_in = _B_setup()

    return {
        "A_x": _A_in["x"],
        "A_wqkv": _A_in["wqkv"],
        "A_w_phi": _A_in["w_phi"],
        "A_wo": _A_in["wo"],
        "B_x": _B_in["x"],
        "B_wqkv": _B_in["wqkv"],
        "B_wo": _B_in["wo"],
    }

def reference(A_x, A_wqkv, A_w_phi, A_wo, B_x, B_wqkv, B_wo):
    def _A_ref(x, wqkv, w_phi, wo):
        B, S, D = x.shape
        H = 32; Dh = D // H
        qkv = (lambda x, *d: x.permute(*d))((x @ wqkv).reshape(B, S, 3, H, Dh), 2, 0, 3, 1, 4)
        q, k, v = qkv[0], qkv[1], qkv[2]
        pq = torch.einsum("bhsd,hdf->bhsf", q, w_phi)
        pk = torch.einsum("bhsd,hdf->bhsf", k, w_phi)
        phi_q = torch.concatenate([_softmax(pq, axis=-1), _softmax(-pq, axis=-1)], axis=-1)
        phi_k = torch.concatenate([_softmax(pk, axis=-1), _softmax(-pk, axis=-1)], axis=-1)
        kv = torch.einsum("bhsf,bhsd->bhfd", phi_k, v)
        z  = torch.einsum("bhsf->bhf", phi_k)
        num = torch.einsum("bhqf,bhfd->bhqd", phi_q, kv)
        den = torch.einsum("bhqf,bhf->bhq", phi_q, z)[..., None] + 1e-6
        o = num / den
        return (lambda x, *d: x.permute(*d))(o, 0, 2, 1, 3).reshape(B, S, D) @ wo

    def _B_ref(x, wqkv, wo):
        B, S, D = x.shape
        H = 32; Dh = D // H
        qkv = (lambda x, *d: x.permute(*d))((x @ wqkv).reshape(B, S, 3, H, Dh), 2, 0, 3, 1, 4)
        q, k, v = qkv[0], qkv[1], qkv[2]
        scale = Dh ** -0.5
        scores = torch.einsum("bhqd,bhkd->bhqk", q, k) * scale
        p = _softmax(scores, axis=-1)
        o = torch.einsum("bhqk,bhkd->bhqd", p, v)
        return (lambda x, *d: x.permute(*d))(o, 0, 2, 1, 3).reshape(B, S, D) @ wo

    a = _A_ref(A_x, A_wqkv, A_w_phi, A_wo)
    b = _B_ref(B_x, B_wqkv, B_wo)
    return torch.concatenate([a, b], axis=-1)
```

```asm
; @launch grid=(256,1,1) block=(512,1,1) lds=163840
.amdgcn_target "amdgcn-amd-amdhsa--gfx950"
.text
.globl concat_heads__linear_kernel_hedgehog__softmax_full_mha__prompt_kernel
.p2align 8
.type concat_heads__linear_kernel_hedgehog__softmax_full_mha__prompt_kernel,@function
concat_heads__linear_kernel_hedgehog__softmax_full_mha__prompt_kernel:
    s_cmp_ge_u32 s2, 256
    s_cbranch_scc1 L_end
    s_load_dwordx2 s[4:5], s[0:1], 32
    s_load_dwordx2 s[8:9], s[0:1], 40
    s_load_dwordx2 s[40:41], s[0:1], 72
    s_load_dwordx2 s[36:37], s[0:1], 64
    s_load_dwordx2 s[12:13], s[0:1], 0
    s_load_dwordx2 s[16:17], s[0:1], 8
    s_cmp_lt_u32 s2, 224
    s_cbranch_scc1 L_noipf
    s_getpc_b64 s[98:99]
L_pc:
    v_lshlrev_b32 v1, 7, v0
    v_cmp_gt_u32 vcc, L_end-L_pc, v1
    s_and_saveexec_b64 s[100:101], vcc
    s_cbranch_execz L_ipfx
    global_load_dword v254, v1, s[98:99]
L_ipfx:
    s_mov_b64 exec, s[100:101]
L_noipf:
    v_lshrrev_b32 v1, 6, v0
    v_and_b32 v0, 63, v0
    v_readfirstlane_b32 s44, v1
    s_and_b32 s75, s2, 7
    s_lshr_b32 s74, s2, 3
    s_mul_i32 s46, s74, 37
    s_lshr_b32 s46, s46, 8
    s_mul_i32 s3, s46, 7
    s_sub_u32 s45, s74, s3
    s_add_u32 s69, s45, s46
    s_and_b32 s3, s75, 1
    s_mul_i32 s3, s3, 7
    s_add_u32 s45, s45, s3
    s_lshr_b32 s3, s75, 1
    s_lshl_b32 s3, s3, 2
    s_add_u32 s46, s46, s3
    s_and_b32 s96, s44, 3
    s_lshl_b32 s3, s75, 2
    s_and_b32 s47, s74, 3
    s_add_u32 s47, s47, s3
    s_lshr_b32 s68, s74, 2
    s_lshr_b32 s71, s74, 3
    s_add_u32 s71, s71, s3
    s_and_b32 s72, s74, 7
    s_mov_b32 s76, 0x40000
    s_and_b32 s77, s44, 1
    s_lshr_b32 s78, s96, 1
    s_cmp_lt_u32 s44, 4
    s_cselect_b32 s97, 0, 0x740000
    v_mov_b32 v248, 0
    v_mov_b32 v246, 157696
    v_mov_b32 v247, 1
    v_lshrrev_b32 v1, 3, v0
    v_and_b32 v2, 7, v0
    v_lshrrev_b32 v3, 1, v1
    v_xor_b32 v2, v2, v3
    v_mul_u32_u24 v1, 1152, v1
    v_lshl_add_u32 v228, v2, 4, v1
    v_xor_b32 v2, 4, v2
    v_lshl_add_u32 v229, v2, 4, v1
    v_add_u32 v229, 8192, v229
    v_add_u32 v230, 16384, v228
    v_add_u32 v231, 16384, v229
    v_lshrrev_b32 v1, 4, v0
    v_lshlrev_b32 v2, 2, v1
    v_sub_u32 v2, v0, v2
    v_and_b32 v2, 15, v2
    v_mul_u32_u24 v1, 3456, v1
    v_lshl_add_u32 v5, v2, 4, v1
    s_cmp_eq_u32 s45, 13
    s_cselect_b32 s3, 8, 16
    v_cmp_gt_u32 vcc, s3, v2
    v_mov_b32 v7, 0x40000000
    s_nop 0
    v_cndmask_b32 v232, v7, v5, vcc
    v_add_u32 v233, 12800, v232
    v_add_u32 v234, 25600, v232
    v_add_u32 v235, 38400, v232
    s_lshl_b32 s98, s46, 2
    s_add_u32 s98, s98, s96
    s_mul_i32 s98, s98, 36864
    s_mul_i32 s99, s96, 55296
    s_lshl_b32 s3, s45, 8
    s_add_u32 s99, s99, s3
    s_mov_b32 s6, 0x240000
    s_mov_b32 s7, 0x20000
    s_mov_b32 s10, 0x1e6000
    s_mov_b32 s11, 0x20000
    s_cmp_eq_u32 s97, 0
    s_cbranch_scc1 L_pset
    s_setprio 1
    s_waitcnt lgkmcnt(0)
    s_cmp_ge_u32 s74, 28
    s_cbranch_scc1 L_lset
    s_lshl_b32 s3, s96, 12
    s_add_u32 m0, s3, 0
    s_add_u32 vcc_lo, s98, 0
    s_add_u32 vcc_hi, s99, 0
    buffer_load_dwordx4 v228, s[4:7], vcc_lo offen offset:0 lds
    buffer_load_dwordx4 v229, s[4:7], vcc_lo offen offset:1024 lds
    buffer_load_dwordx4 v230, s[4:7], vcc_lo offen offset:2048 lds
    buffer_load_dwordx4 v231, s[4:7], vcc_lo offen offset:3072 lds
    s_add_u32 m0, s3, 16384
    s_nop 0
    buffer_load_dwordx4 v232, s[8:11], vcc_hi offen offset:0 lds
    buffer_load_dwordx4 v233, s[8:11], vcc_hi offen offset:1024 lds
    buffer_load_dwordx4 v234, s[8:11], vcc_hi offen offset:2048 lds
    buffer_load_dwordx4 v235, s[8:11], vcc_hi offen offset:3072 lds
    s_lshl_b32 s3, s96, 12
    s_add_u32 m0, s3, 32768
    s_add_u32 vcc_lo, s98, 128
    s_add_u32 vcc_hi, s99, 221184
    buffer_load_dwordx4 v228, s[4:7], vcc_lo offen offset:0 lds
    buffer_load_dwordx4 v229, s[4:7], vcc_lo offen offset:1024 lds
    buffer_load_dwordx4 v230, s[4:7], vcc_lo offen offset:2048 lds
    buffer_load_dwordx4 v231, s[4:7], vcc_lo offen offset:3072 lds
    s_add_u32 m0, s3, 49152
    s_nop 0
    buffer_load_dwordx4 v232, s[8:11], vcc_hi offen offset:0 lds
    buffer_load_dwordx4 v233, s[8:11], vcc_hi offen offset:1024 lds
    buffer_load_dwordx4 v234, s[8:11], vcc_hi offen offset:2048 lds
    buffer_load_dwordx4 v235, s[8:11], vcc_hi offen offset:3072 lds
    s_branch L_lset
L_pset:
    s_mov_b32 s64, 0xdd9a4
    s_cmp_eq_u32 s45, 1
    s_cselect_b32 s64, 0xedea28, s64
    s_cmp_eq_u32 s45, 2
    s_cselect_b32 s64, 0x1dab060, s64
    s_cmp_eq_u32 s45, 3
    s_cselect_b32 s64, 0x2bcc0e0, s64
    s_cmp_eq_u32 s45, 4
    s_cselect_b32 s64, 0x39dd162, s64
    s_cmp_eq_u32 s45, 5
    s_cselect_b32 s64, 0x47de1e6, s64
    s_cmp_eq_u32 s45, 6
    s_cselect_b32 s64, 0x569a820, s64
    s_cmp_eq_u32 s45, 7
    s_cselect_b32 s64, 0x64bb8a0, s64
    s_cmp_eq_u32 s45, 8
    s_cselect_b32 s64, 0x72dc920, s64
    s_lshr_b32 s65, s64, 20
    v_mov_b32 v39, s64
    s_lshl_b32 s79, s46, 2
    s_lshl_b32 s3, s77, 1
    s_add_u32 s79, s79, s3
    s_cmp_le_u32 s45, 4
    s_cselect_b32 s66, 1, 0
    s_cmp_eq_u32 s97, 0
    s_cselect_b32 s66, s66, 0
    s_cmp_ge_u32 s74, 28
    s_cselect_b32 s67, 1, 0
    v_lshlrev_b32 v244, 4, v0
    v_lshlrev_b32 v245, 2, v0
    v_and_b32 v1, 31, v0
    v_lshrrev_b32 v2, 5, v0
    v_bfe_u32 v3, v0, 1, 3
    v_xor_b32 v3, v3, v2
    s_lshl_b32 s3, s77, 13
    v_lshl_add_u32 v4, v1, 7, s3
    v_xor_b32 v5, 0, v3
    v_lshl_add_u32 v24, v5, 4, v4
    v_xor_b32 v5, 2, v3
    v_lshl_add_u32 v25, v5, 4, v4
    v_xor_b32 v5, 4, v3
    v_lshl_add_u32 v26, v5, 4, v4
    v_xor_b32 v5, 6, v3
    v_lshl_add_u32 v27, v5, 4, v4
    v_bfe_u32 v3, v0, 2, 2
    v_and_b32 v4, 3, v0
    v_bfe_u32 v5, v0, 4, 1
    v_lshl_add_u32 v4, v5, 2, v4
    v_lshl_add_u32 v5, v2, 3, v3
    v_lshlrev_b32 v5, 8, v5
    v_add_u32 v5, 16384, v5
    v_lshlrev_b32 v3, 2, v3
    s_lshl_b32 s3, s78, 4
    v_add_u32 v28, s3, v4
    v_add_u32 v29, s3, v4
    v_add_u32 v29, 8, v29
    s_cmp_ge_u32 s45, 9
    s_cbranch_scc1 L_mg01
    v_lshrrev_b32 v6, 2, v4
    v_and_b32 v7, 1, v4
    v_lshl_add_u32 v6, v6, 1, v7
    s_lshl_b32 s3, s78, 3
    s_add_u32 s3, s3, s65
    v_add_u32 v6, s3, v6
    v_lshrrev_b32 v7, 2, v6
    v_mul_u32_u24 v7, 9, v7
    v_and_b32 v1, 1, v6
    v_lshl_add_u32 v7, v1, 1, v7
    v_bfe_u32 v1, v6, 1, 1
    v_mul_u32_u24 v1, 5, v1
    v_bfe_u32 v6, v4, 1, 1
    v_add3_u32 v7, v7, v1, v6
    s_lshl_b32 s3, s45, 5
    v_subrev_u32 v28, s3, v7
    v_add_u32 v29, 9, v28
    s_cmp_eq_u32 s78, 0
    s_cbranch_scc1 L_mg01
    v_mul_u32_u24 v6, 5, v4
    v_lshrrev_b32 v6, v6, v39
    v_and_b32 v6, 31, v6
    v_cmp_gt_u32 vcc, 4, v4
    v_add_u32 v29, 24, v4
    s_nop 0
    v_cndmask_b32 v29, v29, v6, vcc
L_mg01:
    v_lshrrev_b32 v6, 1, v28
    v_add_u32 v6, v6, v3
    v_and_b32 v6, 15, v6
    v_lshl_add_u32 v6, v6, 4, v5
    v_and_b32 v28, 1, v28
    v_lshl_add_u32 v28, v28, 3, v6
    v_lshrrev_b32 v6, 1, v29
    v_add_u32 v6, v6, v3
    v_and_b32 v6, 15, v6
    v_lshl_add_u32 v6, v6, 4, v5
    v_and_b32 v29, 1, v29
    v_lshl_add_u32 v29, v29, 3, v6
    s_waitcnt lgkmcnt(0)
    s_load_dwordx2 s[32:33], s[0:1], 56
    s_mov_b32 s42, 0x1800000
    s_mov_b32 s43, 0x20000
    s_mov_b32 s38, 0x100
    s_mov_b32 s39, 0x20000
    s_mov_b32 s14, 0x240000
    s_mov_b32 s15, 0x20000
    s_mov_b32 s18, 0x1e6000
    s_mov_b32 s19, 0x20000
    s_mov_b32 s34, 0x480000
    s_mov_b32 s35, 0x20000
    s_or_b32 s3, s2, s44
    s_cmp_lg_u32 s3, 0
    s_cbranch_scc1 L_notok2
    s_mov_b32 s48, 0x1438000
    buffer_load_dword v10, v248, s[40:43], s48 offen sc1
L_notok2:
    s_cmp_lg_u32 s44, 1
    s_cbranch_scc1 L_nocnt
    v_lshlrev_b32 v1, 2, v0
    v_add_u32 v1, 157696, v1
    ds_write_b32 v1, v248
L_nocnt:
    s_cmp_lg_u32 s67, 0
    s_cbranch_scc1 L_pidle0
    s_waitcnt lgkmcnt(0)
    s_cmp_ge_u32 s45, 9
    s_cbranch_scc1 L_epiS
    v_and_b32 v1, 31, v0
    v_lshrrev_b32 v2, 5, v0
    s_mul_i32 s49, s79, 2560
    s_lshl_b32 s3, s78, 3
    s_add_u32 s3, s3, s65
    v_add_u32 v3, s3, v1
    v_lshrrev_b32 v4, 2, v3
    v_mul_u32_u24 v4, 9, v4
    v_and_b32 v5, 1, v3
    v_lshl_add_u32 v4, v5, 1, v4
    v_bfe_u32 v5, v3, 1, 1
    v_mad_u32_u24 v8, v5, 5, v4
    v_subrev_u32 v3, 4, v1
    v_mul_u32_u24 v5, 5, v3
    v_lshrrev_b32 v5, v5, v39
    v_and_b32 v5, 31, v5
    v_cmp_gt_u32 vcc, 4, v3
    v_add_u32 v4, 24, v3
    s_nop 0
    v_cndmask_b32 v4, v4, v5, vcc
    s_lshl_b32 s52, s45, 5
    s_cmp_eq_u32 s78, 0
    s_cselect_b32 s3, 32, 4
    v_cmp_gt_u32 vcc, s3, v1
    v_add_u32 v4, s52, v4
    s_add_u32 s49, s49, 0xffd40000
    v_cndmask_b32 v4, v4, v8, vcc
    v_mul_u32_u24 v3, 7282, v4
    v_lshrrev_b32 v3, 16, v3
    v_mul_u32_u24 v5, 9, v3
    v_sub_u32 v8, v4, v5
    v_cmp_lt_u32 vcc, 4, v8
    v_lshlrev_b32 v3, 1, v3
    v_subrev_u32 v9, 5, v8
    v_addc_co_u32 v4, vcc, 0, v3, vcc
    v_min_u32 v9, v8, v9
    s_lshl_b32 s48, s79, 10
    v_lshl_add_u32 v6, v4, 16, s48
    v_mul_u32_u24 v5, 163840, v4
    v_cmp_gt_u32 vcc, 32, v4
    v_add_u32 v5, s49, v5
    s_lshl_b32 s50, s79, 8
    s_add_u32 s50, s50, 0x200000
    v_cndmask_b32 v6, v5, v6, vcc
    v_lshrrev_b32 v4, 1, v9
    v_lshl_add_u32 v6, v4, 9, v6
    v_and_b32 v4, 1, v9
    v_lshl_add_u32 v6, v4, 3, v6
    v_lshl_add_u32 v4, v3, 13, s50
    v_mul_u32_u24 v5, 163840, v3
    s_add_u32 s51, s49, 166144
    v_add_u32 v5, s51, v5
    v_mov_b32 v7, 2576
    v_mov_b32 v9, 1040
    v_cndmask_b32 v4, v5, v4, vcc
    v_cndmask_b32 v7, v7, v9, vcc
    v_mov_b32 v5, 2568
    v_mov_b32 v9, 264
    v_cndmask_b32 v5, v5, v9, vcc
    v_mov_b32 v9, 0x3eae1a93
    v_cndmask_b32 v9, 1.0, v9, vcc
    v_cmp_eq_u32 vcc, 4, v8
    v_lshlrev_b32 v2, 2, v2
    s_nop 0
    v_cndmask_b32 v6, v6, v4, vcc
    v_cndmask_b32 v7, v7, v5, vcc
    ds_bpermute_b32 v72, v2, v6 offset:0
    ds_bpermute_b32 v73, v2, v7 offset:0
    ds_bpermute_b32 v84, v2, v9 offset:0
    ds_bpermute_b32 v74, v2, v6 offset:8
    ds_bpermute_b32 v75, v2, v7 offset:8
    ds_bpermute_b32 v85, v2, v9 offset:8
    ds_bpermute_b32 v76, v2, v6 offset:16
    ds_bpermute_b32 v77, v2, v7 offset:16
    ds_bpermute_b32 v86, v2, v9 offset:16
    ds_bpermute_b32 v78, v2, v6 offset:24
    ds_bpermute_b32 v79, v2, v7 offset:24
    ds_bpermute_b32 v87, v2, v9 offset:24
    ds_bpermute_b32 v80, v2, v6 offset:32
    ds_bpermute_b32 v81, v2, v7 offset:32
    ds_bpermute_b32 v88, v2, v9 offset:32
    ds_bpermute_b32 v82, v2, v6 offset:40
    ds_bpermute_b32 v83, v2, v7 offset:40
    ds_bpermute_b32 v89, v2, v9 offset:40
    s_waitcnt lgkmcnt(0)
    v_and_b32 v3, 31, v73
    v_mad_u32_u24 v72, v1, v3, v72
    v_sub_u32 v3, v73, v3
    v_add_u32 v73, v72, v3
    v_and_b32 v3, 31, v75
    v_mad_u32_u24 v74, v1, v3, v74
    v_sub_u32 v3, v75, v3
    v_add_u32 v75, v74, v3
    v_and_b32 v3, 31, v77
    v_mad_u32_u24 v76, v1, v3, v76
    v_sub_u32 v3, v77, v3
    v_add_u32 v77, v76, v3
    v_and_b32 v3, 31, v79
    v_mad_u32_u24 v78, v1, v3, v78
    v_sub_u32 v3, v79, v3
    v_add_u32 v79, v78, v3
    v_and_b32 v3, 31, v81
    v_mad_u32_u24 v80, v1, v3, v80
    v_sub_u32 v3, v81, v3
    v_add_u32 v81, v80, v3
    v_and_b32 v3, 31, v83
    v_mad_u32_u24 v82, v1, v3, v82
    v_sub_u32 v3, v83, v3
    v_add_u32 v83, v82, v3
L_epiD:
    s_mul_i32 s3, s96, 6656
    s_add_u32 s3, s3, 131072
    v_add_u32 v1, s3, v244
    ds_write_b128 v1, v[24:27] offset:0
    ds_write_b128 v1, v[28:31] offset:1024
    ds_write_b128 v1, v[72:75] offset:2048
    ds_write_b128 v1, v[76:79] offset:3072
    ds_write_b128 v1, v[80:83] offset:4096
    s_or_b32 s3, s2, s44
    s_cmp_lg_u32 s3, 0
    s_cbranch_scc1 L_notok3
    s_mov_b32 s48, 0x1438000
    s_mov_b32 s49, 1664525
    s_waitcnt vmcnt(0)
    v_mul_lo_u32 v6, v10, s49
    v_add_u32 v6, 0x3c6ef35f, v6
    v_mov_b32 v7, 1
    s_mov_b64 exec, 1
    buffer_store_dwordx2 v[6:7], v248, s[36:39], 0 offen sc1
    buffer_store_dword v6, v248, s[40:43], s48 offen sc1
    s_mov_b64 exec, -1
L_notok3:
    s_waitcnt lgkmcnt(0)
    s_mov_b32 s54, 0
    s_branch L_gemm
L_epiS:
    v_and_b32 v1, 31, v0
    v_lshrrev_b32 v2, 5, v0
    s_mul_i32 s49, s79, 2560
    s_add_u32 s49, s49, 0x240000
    s_sub_u32 s50, s45, 9
    s_lshl_b32 s50, s50, 7
    s_lshl_b32 s3, s78, 6
    s_add_u32 s3, s3, s50
    s_add_u32 s3, s3, 0
    v_add_u32 v3, s3, v1
    v_mul_u32_u24 v4, 3641, v3
    v_lshrrev_b32 v4, 16, v4
    v_mul_u32_u24 v5, 18, v4
    v_sub_u32 v3, v3, v5
    v_and_b32 v5, 1, v4
    v_lshlrev_b32 v5, 1, v5
    v_sub_u32 v3, v3, v5
    v_add_u32 v5, 18, v3
    v_min_u32 v3, v3, v5
    v_mul_u32_u24 v5, 163840, v4
    v_add_u32 v5, s49, v5
    v_lshl_add_u32 v5, v3, 4, v5
    v_lshl_add_u32 v6, v2, 8, v5
    v_add_u32 v6, 1024, v6
    v_lshl_add_u32 v7, v2, 5, v5
    v_add_u32 v7, 1792, v7
    v_cmp_gt_u32 vcc, 16, v3
    v_add_u32 v8, 512, v6
    v_add_u32 v9, 64, v7
    v_cndmask_b32 v6, v7, v6, vcc
    v_cndmask_b32 v8, v9, v8, vcc
    v_cmp_gt_u32 vcc, 32, v4
    v_mov_b32 v7, 0x40000000
    s_nop 0
    v_cndmask_b32 v72, v7, v6, vcc
    v_cndmask_b32 v73, v7, v8, vcc
    s_lshl_b32 s3, s78, 6
    s_add_u32 s3, s3, s50
    s_add_u32 s3, s3, 32
    v_add_u32 v3, s3, v1
    v_mul_u32_u24 v4, 3641, v3
    v_lshrrev_b32 v4, 16, v4
    v_mul_u32_u24 v5, 18, v4
    v_sub_u32 v3, v3, v5
    v_and_b32 v5, 1, v4
    v_lshlrev_b32 v5, 1, v5
    v_sub_u32 v3, v3, v5
    v_add_u32 v5, 18, v3
    v_min_u32 v3, v3, v5
    v_mul_u32_u24 v5, 163840, v4
    v_add_u32 v5, s49, v5
    v_lshl_add_u32 v5, v3, 4, v5
    v_lshl_add_u32 v6, v2, 8, v5
    v_add_u32 v6, 1024, v6
    v_lshl_add_u32 v7, v2, 5, v5
    v_add_u32 v7, 1792, v7
    v_cmp_gt_u32 vcc, 16, v3
    v_add_u32 v8, 512, v6
    v_add_u32 v9, 64, v7
    v_cndmask_b32 v6, v7, v6, vcc
    v_cndmask_b32 v8, v9, v8, vcc
    v_cmp_gt_u32 vcc, 32, v4
    v_mov_b32 v7, 0x40000000
    s_nop 0
    v_cndmask_b32 v74, v7, v6, vcc
    v_cndmask_b32 v75, v7, v8, vcc
    s_add_u32 s3, s50, 17
    s_mul_i32 s3, s3, 3641
    s_lshr_b32 s3, s3, 16
    v_and_b32 v3, 7, v0
    v_add_u32 v3, s3, v3
    v_mul_u32_u24 v4, 18, v3
    s_add_u32 s50, s50, 128
    s_min_u32 s50, s50, 576
    v_cmp_gt_u32 vcc, s50, v4
    v_cmp_gt_u32 s[52:53], 16, v0
    s_and_b64 vcc, vcc, s[52:53]
    v_mul_u32_u24 v3, 163840, v3
    v_bfe_u32 v4, v0, 3, 1
    v_mul_u32_u24 v4, 2560, v4
    v_add3_u32 v3, v3, v4, s49
    v_add_u32 v3, 2176, v3
    v_cndmask_b32 v76, v7, v3, vcc
    v_mov_b32 v77, v7
    v_mov_b32 v78, v7
    v_mov_b32 v79, v7
    v_mov_b32 v80, v7
    v_mov_b32 v81, v7
    v_mov_b32 v82, v7
    v_mov_b32 v83, v7
    s_branch L_epiD
L_gemm:
    v_add_u32 v32, s54, v24
    v_add_u32 v33, s54, v25
    v_add_u32 v34, s54, v26
    v_add_u32 v35, s54, v27
    v_add_u32 v36, s54, v28
    v_add_u32 v37, s54, v29
    s_add_u32 s54, s54, 0x8000
    s_and_b32 s54, s54, 0x1ffff
    s_mov_b32 s55, 9
    s_mov_b32 s53, 0
    s_cmp_ge_u32 s45, 9
    s_barrier
    s_cbranch_scc1 L_gS0
L_gN0:
    ds_read_b64_tr_b16 v[184:185], v36 offset:0
    ds_read_b64_tr_b16 v[186:187], v36 offset:1024
    ds_read_b128 v[176:179], v32 offset:0
    ds_read_b128 v[180:183], v32 offset:4096
    ds_read_b64_tr_b16 v[188:189], v37 offset:0
    ds_read_b64_tr_b16 v[190:191], v37 offset:1024
    ds_read_b64_tr_b16 v[200:201], v36 offset:4096
    ds_read_b64_tr_b16 v[202:203], v36 offset:5120
    ds_read_b128 v[192:195], v33 offset:0
    ds_read_b128 v[196:199], v33 offset:4096
    ds_read_b64_tr_b16 v[204:205], v37 offset:4096
    ds_read_b64_tr_b16 v[206:207], v37 offset:5120
    s_waitcnt lgkmcnt(6)
    v_mfma_f32_32x32x16_bf16 v[96:111], v[184:187], v[176:179], 0
    ds_read_b64_tr_b16 v[48:49], v36 offset:8192
    ds_read_b64_tr_b16 v[50:51], v36 offset:9216
    ds_read_b128 v[40:43], v34 offset:0
    v_mfma_f32_32x32x16_bf16 v[112:127], v[184:187], v[180:183], 0
    ds_read_b128 v[44:47], v34 offset:4096
    ds_read_b64_tr_b16 v[52:53], v37 offset:8192
    ds_read_b64_tr_b16 v[54:55], v37 offset:9216
    v_mfma_f32_32x32x16_bf16 v[128:143], v[188:191], v[176:179], 0
    v_mfma_f32_32x32x16_bf16 v[144:159], v[188:191], v[180:183], 0
    s_branch L_gNm
L_gN:
    s_barrier
    s_cmp_lg_u32 s53, 0
    s_cbranch_scc1 L_gNs
L_gNb:
    v_mfma_f32_32x32x16_bf16 v[96:111], v[48:51], v[40:43], v[96:111]
    ds_read_b64_tr_b16 v[184:185], v36 offset:0
    ds_read_b64_tr_b16 v[186:187], v36 offset:1024
    ds_read_b128 v[176:179], v32 offset:0
    v_mfma_f32_32x32x16_bf16 v[112:127], v[48:51], v[44:47], v[112:127]
    ds_read_b128 v[180:183], v32 offset:4096
    ds_read_b64_tr_b16 v[188:189], v37 offset:0
    ds_read_b64_tr_b16 v[190:191], v37 offset:1024
    v_mfma_f32_32x32x16_bf16 v[128:143], v[52:55], v[40:43], v[128:143]
    v_mfma_f32_32x32x16_bf16 v[144:159], v[52:55], v[44:47], v[144:159]
    v_mfma_f32_32x32x16_bf16 v[96:111], v[64:67], v[56:59], v[96:111]
    ds_read_b64_tr_b16 v[200:201], v36 offset:4096
    ds_read_b64_tr_b16 v[202:203], v36 offset:5120
    ds_read_b128 v[192:195], v33 offset:0
    v_mfma_f32_32x32x16_bf16 v[112:127], v[64:67], v[60:63], v[112:127]
    ds_read_b128 v[196:199], v33 offset:4096
    ds_read_b64_tr_b16 v[204:205], v37 offset:4096
    ds_read_b64_tr_b16 v[206:207], v37 offset:5120
    v_mfma_f32_32x32x16_bf16 v[128:143], v[68:71], v[56:59], v[128:143]
    v_mfma_f32_32x32x16_bf16 v[144:159], v[68:71], v[60:63], v[144:159]
    s_waitcnt lgkmcnt(6)
    v_mfma_f32_32x32x16_bf16 v[96:111], v[184:187], v[176:179], v[96:111]
    ds_read_b64_tr_b16 v[48:49], v36 offset:8192
    ds_read_b64_tr_b16 v[50:51], v36 offset:9216
    ds_read_b128 v[40:43], v34 offset:0
    v_mfma_f32_32x32x16_bf16 v[112:127], v[184:187], v[180:183], v[112:127]
    ds_read_b128 v[44:47], v34 offset:4096
    ds_read_b64_tr_b16 v[52:53], v37 offset:8192
    ds_read_b64_tr_b16 v[54:55], v37 offset:9216
    v_mfma_f32_32x32x16_bf16 v[128:143], v[188:191], v[176:179], v[128:143]
    v_mfma_f32_32x32x16_bf16 v[144:159], v[188:191], v[180:183], v[144:159]
L_gNm:
    s_waitcnt lgkmcnt(6)
L_gNn:
    v_mfma_f32_32x32x16_bf16 v[96:111], v[200:203], v[192:195], v[96:111]
    ds_read_b64_tr_b16 v[64:65], v36 offset:12288
    ds_read_b64_tr_b16 v[66:67], v36 offset:13312
    ds_read_b128 v[56:59], v35 offset:0
    v_mfma_f32_32x32x16_bf16 v[112:127], v[200:203], v[196:199], v[112:127]
    ds_read_b128 v[60:63], v35 offset:4096
    ds_read_b64_tr_b16 v[68:69], v37 offset:12288
    ds_read_b64_tr_b16 v[70:71], v37 offset:13312
    v_add_u32 v32, s54, v24
    v_add_u32 v33, s54, v25
    v_add_u32 v34, s54, v26
    v_add_u32 v35, s54, v27
    v_add_u32 v36, s54, v28
    v_add_u32 v37, s54, v29
    s_add_u32 s54, s54, 0x8000
    s_and_b32 s54, s54, 0x1ffff
    v_mfma_f32_32x32x16_bf16 v[128:143], v[204:207], v[192:195], v[128:143]
    s_cmp_ge_u32 s55, 7
    s_cbranch_scc1 L_w84
    s_waitcnt vmcnt(0)
L_w84:
    s_cmp_lg_u32 s55, 2
    s_cbranch_scc1 L_lo5
    s_setprio 0
L_lo5:
    s_sub_u32 s55, s55, 1
    s_cmp_lg_u32 s55, 0
    v_mfma_f32_32x32x16_bf16 v[144:159], v[204:207], v[196:199], v[144:159]
    s_waitcnt vmcnt(8) lgkmcnt(0)
    s_cbranch_scc1 L_gN
    s_cmp_lg_u32 s97, 0
    s_cbranch_scc1 L_gfN
    s_barrier
    s_setprio 2
    ds_read_b32 v250, v246 offset:40
L_gfN:
    v_mfma_f32_32x32x16_bf16 v[96:111], v[48:51], v[40:43], v[96:111]
    v_mfma_f32_32x32x16_bf16 v[112:127], v[48:51], v[44:47], v[112:127]
    v_mfma_f32_32x32x16_bf16 v[96:111], v[64:67], v[56:59], v[96:111]
    v_mfma_f32_32x32x16_bf16 v[112:127], v[64:67], v[60:63], v[112:127]
    v_mfma_f32_32x32x16_bf16 v[128:143], v[52:55], v[40:43], v[128:143]
    v_mfma_f32_32x32x16_bf16 v[144:159], v[52:55], v[44:47], v[144:159]
    v_mfma_f32_32x32x16_bf16 v[128:143], v[68:71], v[56:59], v[128:143]
    v_mfma_f32_32x32x16_bf16 v[144:159], v[68:71], v[60:63], v[144:159]
    s_cmp_eq_u32 s97, 0
    s_cbranch_scc1 L_lo6
    s_setprio 1
L_lo6:
    s_nop 5
    s_cmp_eq_u32 s66, 0
    s_cbranch_scc1 L_nosc7
    v_mul_f32 v96, v84, v96
    v_mul_f32 v97, v84, v97
    v_mul_f32 v98, v84, v98
    v_mul_f32 v99, v84, v99
    v_mul_f32 v100, v84, v100
    v_mul_f32 v101, v84, v101
    v_mul_f32 v102, v84, v102
    v_mul_f32 v103, v84, v103
    v_mul_f32 v104, v85, v104
    v_mul_f32 v105, v85, v105
    v_mul_f32 v106, v85, v106
    v_mul_f32 v107, v85, v107
    v_mul_f32 v108, v85, v108
    v_mul_f32 v109, v85, v109
    v_mul_f32 v110, v85, v110
    v_mul_f32 v111, v85, v111
    v_mul_f32 v112, v84, v112
    v_mul_f32 v113, v84, v113
    v_mul_f32 v114, v84, v114
    v_mul_f32 v115, v84, v115
    v_mul_f32 v116, v84, v116
    v_mul_f32 v117, v84, v117
    v_mul_f32 v118, v84, v118
    v_mul_f32 v119, v84, v119
    v_mul_f32 v120, v85, v120
    v_mul_f32 v121, v85, v121
    v_mul_f32 v122, v85, v122
    v_mul_f32 v123, v85, v123
    v_mul_f32 v124, v85, v124
    v_mul_f32 v125, v85, v125
    v_mul_f32 v126, v85, v126
    v_mul_f32 v127, v85, v127
L_nosc7:
    v_cvt_pk_bf16_f32 v96, v96, v97
    v_cvt_pk_bf16_f32 v97, v98, v99
    v_cvt_pk_bf16_f32 v98, v100, v101
    v_cvt_pk_bf16_f32 v99, v102, v103
    buffer_store_dwordx4 v[96:99], v72, s[40:43], 0 offen sc1
    v_cvt_pk_bf16_f32 v104, v104, v105
    v_cvt_pk_bf16_f32 v105, v106, v107
    v_cvt_pk_bf16_f32 v106, v108, v109
    v_cvt_pk_bf16_f32 v107, v110, v111
    buffer_store_dwordx4 v[104:107], v74, s[40:43], 0 offen sc1
    v_cvt_pk_bf16_f32 v112, v112, v113
    v_cvt_pk_bf16_f32 v113, v114, v115
    v_cvt_pk_bf16_f32 v114, v116, v117
    v_cvt_pk_bf16_f32 v115, v118, v119
    buffer_store_dwordx4 v[112:115], v73, s[40:43], 0 offen sc1
    v_cvt_pk_bf16_f32 v120, v120, v121
    v_cvt_pk_bf16_f32 v121, v122, v123
    v_cvt_pk_bf16_f32 v122, v124, v125
    v_cvt_pk_bf16_f32 v123, v126, v127
    buffer_store_dwordx4 v[120:123], v75, s[40:43], 0 offen sc1
    s_cmp_lg_u32 s97, 0
    s_cbranch_scc1 L_mid8
    s_barrier
L_mid8:
    s_cmp_lg_u32 s78, 0
    s_cbranch_scc1 L_emisc
    s_cmp_eq_u32 s66, 0
    s_cbranch_scc1 L_nosc9
    v_mul_f32 v128, v86, v128
    v_mul_f32 v129, v86, v129
    v_mul_f32 v130, v86, v130
    v_mul_f32 v131, v86, v131
    v_mul_f32 v132, v86, v132
    v_mul_f32 v133, v86, v133
    v_mul_f32 v134, v86, v134
    v_mul_f32 v135, v86, v135
    v_mul_f32 v136, v87, v136
    v_mul_f32 v137, v87, v137
    v_mul_f32 v138, v87, v138
    v_mul_f32 v139, v87, v139
    v_mul_f32 v140, v87, v140
    v_mul_f32 v141, v87, v141
    v_mul_f32 v142, v87, v142
    v_mul_f32 v143, v87, v143
    v_mul_f32 v144, v86, v144
    v_mul_f32 v145, v86, v145
    v_mul_f32 v146, v86, v146
    v_mul_f32 v147, v86, v147
    v_mul_f32 v148, v86, v148
    v_mul_f32 v149, v86, v149
    v_mul_f32 v150, v86, v150
    v_mul_f32 v151, v86, v151
    v_mul_f32 v152, v87, v152
    v_mul_f32 v153, v87, v153
    v_mul_f32 v154, v87, v154
    v_mul_f32 v155, v87, v155
    v_mul_f32 v156, v87, v156
    v_mul_f32 v157, v87, v157
    v_mul_f32 v158, v87, v158
    v_mul_f32 v159, v87, v159
L_nosc9:
    v_cvt_pk_bf16_f32 v128, v128, v129
    v_cvt_pk_bf16_f32 v129, v130, v131
    v_cvt_pk_bf16_f32 v130, v132, v133
    v_cvt_pk_bf16_f32 v131, v134, v135
    buffer_store_dwordx4 v[128:131], v76, s[40:43], 0 offen sc1
    v_cvt_pk_bf16_f32 v136, v136, v137
    v_cvt_pk_bf16_f32 v137, v138, v139
    v_cvt_pk_bf16_f32 v138, v140, v141
    v_cvt_pk_bf16_f32 v139, v142, v143
    buffer_store_dwordx4 v[136:139], v78, s[40:43], 0 offen sc1
    v_cvt_pk_bf16_f32 v144, v144, v145
    v_cvt_pk_bf16_f32 v145, v146, v147
    v_cvt_pk_bf16_f32 v146, v148, v149
    v_cvt_pk_bf16_f32 v147, v150, v151
    buffer_store_dwordx4 v[144:147], v77, s[40:43], 0 offen sc1
    v_cvt_pk_bf16_f32 v152, v152, v153
    v_cvt_pk_bf16_f32 v153, v154, v155
    v_cvt_pk_bf16_f32 v154, v156, v157
    v_cvt_pk_bf16_f32 v155, v158, v159
    buffer_store_dwordx4 v[152:155], v79, s[40:43], 0 offen sc1
    s_branch L_epi_done
L_emisc:
    s_cmp_eq_u32 s66, 0
    s_cbranch_scc1 L_nosc10
    v_mul_f32 v128, v86, v128
    v_mul_f32 v129, v86, v129
    v_mul_f32 v130, v86, v130
    v_mul_f32 v131, v86, v131
    v_mul_f32 v132, v87, v132
    v_mul_f32 v133, v87, v133
    v_mul_f32 v134, v87, v134
    v_mul_f32 v135, v87, v135
    v_mul_f32 v136, v88, v136
    v_mul_f32 v137, v88, v137
    v_mul_f32 v138, v88, v138
    v_mul_f32 v139, v88, v139
    v_mul_f32 v140, v89, v140
    v_mul_f32 v141, v89, v141
    v_mul_f32 v142, v89, v142
    v_mul_f32 v143, v89, v143
    v_mul_f32 v144, v86, v144
    v_mul_f32 v145, v86, v145
    v_mul_f32 v146, v86, v146
    v_mul_f32 v147, v86, v147
    v_mul_f32 v148, v87, v148
    v_mul_f32 v149, v87, v149
    v_mul_f32 v150, v87, v150
    v_mul_f32 v151, v87, v151
    v_mul_f32 v152, v88, v152
    v_mul_f32 v153, v88, v153
    v_mul_f32 v154, v88, v154
    v_mul_f32 v155, v88, v155
    v_mul_f32 v156, v89, v156
    v_mul_f32 v157, v89, v157
    v_mul_f32 v158, v89, v158
    v_mul_f32 v159, v89, v159
L_nosc10:
    v_cvt_pk_bf16_f32 v128, v128, v129
    v_cvt_pk_bf16_f32 v129, v130, v131
    v_cvt_pk_bf16_f32 v130, v132, v133
    v_cvt_pk_bf16_f32 v131, v134, v135
    buffer_store_dwordx2 v[128:129], v76, s[40:43], 0 offen sc1
    buffer_store_dwordx2 v[130:131], v78, s[40:43], 0 offen sc1
    v_cvt_pk_bf16_f32 v136, v136, v137
    v_cvt_pk_bf16_f32 v137, v138, v139
    v_cvt_pk_bf16_f32 v138, v140, v141
    v_cvt_pk_bf16_f32 v139, v142, v143
    buffer_store_dwordx2 v[136:137], v80, s[40:43], 0 offen sc1
    buffer_store_dwordx2 v[138:139], v82, s[40:43], 0 offen sc1
    v_cvt_pk_bf16_f32 v144, v144, v145
    v_cvt_pk_bf16_f32 v145, v146, v147
    v_cvt_pk_bf16_f32 v146, v148, v149
    v_cvt_pk_bf16_f32 v147, v150, v151
    buffer_store_dwordx2 v[144:145], v77, s[40:43], 0 offen sc1
    buffer_store_dwordx2 v[146:147], v79, s[40:43], 0 offen sc1
    v_cvt_pk_bf16_f32 v152, v152, v153
    v_cvt_pk_bf16_f32 v153, v154, v155
    v_cvt_pk_bf16_f32 v154, v156, v157
    v_cvt_pk_bf16_f32 v155, v158, v159
    buffer_store_dwordx2 v[152:153], v81, s[40:43], 0 offen sc1
    buffer_store_dwordx2 v[154:155], v83, s[40:43], 0 offen sc1
    s_branch L_epi_done
L_gS0:
    ds_read_b64_tr_b16 v[184:185], v36 offset:0
    ds_read_b64_tr_b16 v[186:187], v36 offset:1024
    ds_read_b128 v[176:179], v32 offset:0
    ds_read_b128 v[180:183], v32 offset:4096
    ds_read_b64_tr_b16 v[188:189], v37 offset:0
    ds_read_b64_tr_b16 v[190:191], v37 offset:1024
    ds_read_b64_tr_b16 v[200:201], v36 offset:4096
    ds_read_b64_tr_b16 v[202:203], v36 offset:5120
    ds_read_b128 v[192:195], v33 offset:0
    ds_read_b128 v[196:199], v33 offset:4096
    ds_read_b64_tr_b16 v[204:205], v37 offset:4096
    ds_read_b64_tr_b16 v[206:207], v37 offset:5120
    s_waitcnt lgkmcnt(6)
    v_mfma_f32_32x32x16_bf16 v[96:111], v[176:179], v[184:187], 0
    ds_read_b64_tr_b16 v[48:49], v36 offset:8192
    ds_read_b64_tr_b16 v[50:51], v36 offset:9216
    ds_read_b128 v[40:43], v34 offset:0
    v_mfma_f32_32x32x16_bf16 v[112:127], v[180:183], v[184:187], 0
    ds_read_b128 v[44:47], v34 offset:4096
    ds_read_b64_tr_b16 v[52:53], v37 offset:8192
    ds_read_b64_tr_b16 v[54:55], v37 offset:9216
    v_mfma_f32_32x32x16_bf16 v[128:143], v[176:179], v[188:191], 0
    v_mfma_f32_32x32x16_bf16 v[144:159], v[180:183], v[188:191], 0
    s_branch L_gSm
L_gS:
    s_barrier
    s_cmp_lg_u32 s53, 0
    s_cbranch_scc1 L_gSs
L_gSb:
    v_mfma_f32_32x32x16_bf16 v[96:111], v[40:43], v[48:51], v[96:111]
    ds_read_b64_tr_b16 v[184:185], v36 offset:0
    ds_read_b64_tr_b16 v[186:187], v36 offset:1024
    ds_read_b128 v[176:179], v32 offset:0
    v_mfma_f32_32x32x16_bf16 v[112:127], v[44:47], v[48:51], v[112:127]
    ds_read_b128 v[180:183], v32 offset:4096
    ds_read_b64_tr_b16 v[188:189], v37 offset:0
    ds_read_b64_tr_b16 v[190:191], v37 offset:1024
    v_mfma_f32_32x32x16_bf16 v[128:143], v[40:43], v[52:55], v[128:143]
    v_mfma_f32_32x32x16_bf16 v[144:159], v[44:47], v[52:55], v[144:159]
    v_mfma_f32_32x32x16_bf16 v[96:111], v[56:59], v[64:67], v[96:111]
    ds_read_b64_tr_b16 v[200:201], v36 offset:4096
    ds_read_b64_tr_b16 v[202:203], v36 offset:5120
    ds_read_b128 v[192:195], v33 offset:0
    v_mfma_f32_32x32x16_bf16 v[112:127], v[60:63], v[64:67], v[112:127]
    ds_read_b128 v[196:199], v33 offset:4096
    ds_read_b64_tr_b16 v[204:205], v37 offset:4096
    ds_read_b64_tr_b16 v[206:207], v37 offset:5120
    v_mfma_f32_32x32x16_bf16 v[128:143], v[56:59], v[68:71], v[128:143]
    v_mfma_f32_32x32x16_bf16 v[144:159], v[60:63], v[68:71], v[144:159]
    s_waitcnt lgkmcnt(6)
    v_mfma_f32_32x32x16_bf16 v[96:111], v[176:179], v[184:187], v[96:111]
    ds_read_b64_tr_b16 v[48:49], v36 offset:8192
    ds_read_b64_tr_b16 v[50:51], v36 offset:9216
    ds_read_b128 v[40:43], v34 offset:0
    v_mfma_f32_32x32x16_bf16 v[112:127], v[180:183], v[184:187], v[112:127]
    ds_read_b128 v[44:47], v34 offset:4096
    ds_read_b64_tr_b16 v[52:53], v37 offset:8192
    ds_read_b64_tr_b16 v[54:55], v37 offset:9216
    v_mfma_f32_32x32x16_bf16 v[128:143], v[176:179], v[188:191], v[128:143]
    v_mfma_f32_32x32x16_bf16 v[144:159], v[180:183], v[188:191], v[144:159]
L_gSm:
    s_waitcnt lgkmcnt(6)
L_gSn:
    v_mfma_f32_32x32x16_bf16 v[96:111], v[192:195], v[200:203], v[96:111]
    ds_read_b64_tr_b16 v[64:65], v36 offset:12288
    ds_read_b64_tr_b16 v[66:67], v36 offset:13312
    ds_read_b128 v[56:59], v35 offset:0
    v_mfma_f32_32x32x16_bf16 v[112:127], v[196:199], v[200:203], v[112:127]
    ds_read_b128 v[60:63], v35 offset:4096
    ds_read_b64_tr_b16 v[68:69], v37 offset:12288
    ds_read_b64_tr_b16 v[70:71], v37 offset:13312
    v_add_u32 v32, s54, v24
    v_add_u32 v33, s54, v25
    v_add_u32 v34, s54, v26
    v_add_u32 v35, s54, v27
    v_add_u32 v36, s54, v28
    v_add_u32 v37, s54, v29
    s_add_u32 s54, s54, 0x8000
    s_and_b32 s54, s54, 0x1ffff
    v_mfma_f32_32x32x16_bf16 v[128:143], v[192:195], v[204:207], v[128:143]
    s_cmp_ge_u32 s55, 7
    s_cbranch_scc1 L_w811
    s_waitcnt vmcnt(0)
L_w811:
    s_cmp_lg_u32 s55, 2
    s_cbranch_scc1 L_lo12
    s_setprio 0
L_lo12:
    s_sub_u32 s55, s55, 1
    s_cmp_lg_u32 s55, 0
    v_mfma_f32_32x32x16_bf16 v[144:159], v[196:199], v[204:207], v[144:159]
    s_waitcnt vmcnt(8) lgkmcnt(0)
    s_cbranch_scc1 L_gS
    s_cmp_lg_u32 s97, 0
    s_cbranch_scc1 L_gfS
    s_barrier
    s_setprio 2
    ds_read_b32 v250, v246 offset:40
L_gfS:
    v_mfma_f32_32x32x16_bf16 v[96:111], v[40:43], v[48:51], v[96:111]
    v_mfma_f32_32x32x16_bf16 v[112:127], v[44:47], v[48:51], v[112:127]
    v_mfma_f32_32x32x16_bf16 v[96:111], v[56:59], v[64:67], v[96:111]
    v_mfma_f32_32x32x16_bf16 v[112:127], v[60:63], v[64:67], v[112:127]
    v_mfma_f32_32x32x16_bf16 v[128:143], v[40:43], v[52:55], v[128:143]
    v_mfma_f32_32x32x16_bf16 v[144:159], v[44:47], v[52:55], v[144:159]
    v_mfma_f32_32x32x16_bf16 v[128:143], v[56:59], v[68:71], v[128:143]
    v_mfma_f32_32x32x16_bf16 v[144:159], v[60:63], v[68:71], v[144:159]
    s_cmp_eq_u32 s97, 0
    s_cbranch_scc1 L_lo13
    s_setprio 1
L_lo13:
    v_mov_b32 v4, 0x3f803f80
    v_mov_b32 v5, 0x3f803f80
    v_mov_b32 v6, 0x3f803f80
    v_mov_b32 v7, 0x3f803f80
    s_nop 3
    v_cvt_pk_bf16_f32 v96, v96, v97
    v_cvt_pk_bf16_f32 v97, v98, v99
    v_cvt_pk_bf16_f32 v98, v100, v101
    v_cvt_pk_bf16_f32 v99, v102, v103
    buffer_store_dwordx4 v[96:99], v72, s[40:43], 0 offen offset:0 sc1
    v_cvt_pk_bf16_f32 v104, v104, v105
    v_cvt_pk_bf16_f32 v105, v106, v107
    v_cvt_pk_bf16_f32 v106, v108, v109
    v_cvt_pk_bf16_f32 v107, v110, v111
    buffer_store_dwordx4 v[104:107], v73, s[40:43], 0 offen offset:0 sc1
    v_cvt_pk_bf16_f32 v112, v112, v113
    v_cvt_pk_bf16_f32 v113, v114, v115
    v_cvt_pk_bf16_f32 v114, v116, v117
    v_cvt_pk_bf16_f32 v115, v118, v119
    buffer_store_dwordx4 v[112:115], v72, s[40:43], 0 offen offset:2560 sc1
    v_cvt_pk_bf16_f32 v120, v120, v121
    v_cvt_pk_bf16_f32 v121, v122, v123
    v_cvt_pk_bf16_f32 v122, v124, v125
    v_cvt_pk_bf16_f32 v123, v126, v127
    buffer_store_dwordx4 v[120:123], v73, s[40:43], 0 offen offset:2560 sc1
    s_cmp_lg_u32 s97, 0
    s_cbranch_scc1 L_mid14
    s_barrier
L_mid14:
    v_cvt_pk_bf16_f32 v128, v128, v129
    v_cvt_pk_bf16_f32 v129, v130, v131
    v_cvt_pk_bf16_f32 v130, v132, v133
    v_cvt_pk_bf16_f32 v131, v134, v135
    buffer_store_dwordx4 v[128:131], v74, s[40:43], 0 offen offset:0 sc1
    v_cvt_pk_bf16_f32 v136, v136, v137
    v_cvt_pk_bf16_f32 v137, v138, v139
    v_cvt_pk_bf16_f32 v138, v140, v141
    v_cvt_pk_bf16_f32 v139, v142, v143
    buffer_store_dwordx4 v[136:139], v75, s[40:43], 0 offen offset:0 sc1
    v_cvt_pk_bf16_f32 v144, v144, v145
    v_cvt_pk_bf16_f32 v145, v146, v147
    v_cvt_pk_bf16_f32 v146, v148, v149
    v_cvt_pk_bf16_f32 v147, v150, v151
    buffer_store_dwordx4 v[144:147], v74, s[40:43], 0 offen offset:2560 sc1
    v_cvt_pk_bf16_f32 v152, v152, v153
    v_cvt_pk_bf16_f32 v153, v154, v155
    v_cvt_pk_bf16_f32 v154, v156, v157
    v_cvt_pk_bf16_f32 v155, v158, v159
    buffer_store_dwordx4 v[152:155], v75, s[40:43], 0 offen offset:2560 sc1
    s_cmp_lg_u32 s78, 0
    s_cbranch_scc1 L_epi_done
    buffer_store_dwordx4 v[4:7], v76, s[40:43], 0 offen sc1
L_epi_done:
    s_cmp_lg_u32 s97, 0
    s_cbranch_scc1 L_achain
L_ppath:
    v_and_b32 v1, 31, v0
    v_lshrrev_b32 v2, 5, v0
    v_lshlrev_b32 v3, 4, v1
    v_lshl_add_u32 v3, v2, 8, v3
    v_add_u32 v3, 1024, v3
    v_subrev_u32 v4, 16, v1
    v_lshlrev_b32 v5, 4, v4
    v_lshl_add_u32 v5, v2, 5, v5
    v_add_u32 v5, 2048, v5
    v_cmp_gt_u32 vcc, 2, v4
    v_add_u32 v6, 64, v5
    v_mov_b32 v7, 0x40000000
    v_cndmask_b32 v5, v7, v5, vcc
    v_cndmask_b32 v6, v7, v6, vcc
    v_and_b32 v4, 27, v1
    v_cmp_eq_u32 vcc, 18, v4
    v_mov_b32 v7, 2176
    s_nop 0
    v_cndmask_b32 v5, v5, v7, vcc
    v_cndmask_b32 v6, v6, v7, vcc
    v_cmp_gt_u32 vcc, 16, v1
    v_add_u32 v4, 512, v3
    s_nop 0
    v_cndmask_b32 v252, v5, v3, vcc
    v_cndmask_b32 v253, v6, v4, vcc
    s_bitcmp1_b32 s47, 0
    s_mov_b32 s48, 166144
    s_cselect_b32 s48, 2308, s48
    v_and_b32 v1, 31, v0
    v_mov_b32 v8, v244
    v_lshl_add_u32 v10, v1, 3, s48
    v_lshrrev_b32 v2, 5, v0
    v_mul_u32_u24 v2, 2560, v2
    v_add_u32 v10, v10, v2
    v_mov_b32 v12, v252
    v_mov_b32 v14, v253
    v_add_u32 v9, 5120, v8
    v_add_u32 v11, 5120, v10
    v_add_u32 v13, 5120, v12
    v_add_u32 v15, 5120, v14
    v_lshrrev_b32 v2, 4, v0
    v_add_u32 v2, 1, v2
    v_cmp_gt_u32 vcc, 32, v0
    v_bfe_u32 v3, v0, 3, 1
    v_and_b32 v4, 1, v0
    v_cndmask_b32 v2, 0, v2, vcc
    v_cndmask_b32 v3, v4, v3, vcc
    s_lshl_b32 s50, s78, 3
    v_and_b32 v4, 7, v0
    v_add_u32 v4, s50, v4
    s_lshl_b32 s51, s68, 1
    s_add_u32 s51, s51, s77
    v_mov_b32 v5, s51
    v_cndmask_b32 v4, v5, v4, vcc
    s_lshr_b32 s48, s47, 1
    s_mul_i32 s48, s48, 36
    s_and_b32 s49, s47, 1
    s_lshl_b32 s49, s49, 4
    s_add_u32 s48, s48, s49
    v_mul_u32_u24 v5, 576, v2
    v_mul_u32_u24 v6, 19, v3
    v_add3_u32 v5, v5, v6, s48
    v_lshrrev_b32 v5, 7, v5
    v_lshl_add_u32 v5, v5, 4, v4
    v_lshlrev_b32 v5, 7, v5
    v_add_u32 v249, 0x1420000, v5
    v_lshlrev_b32 v7, 3, v0
    v_mov_b32 v33, 0
    v_mov_b32 v35, 0
    v_mov_b32 v57, 0
    v_mov_b32 v59, 0
    v_mov_b32 v61, 0
    v_mov_b32 v63, 0
    s_lshl_b32 s48, s47, 6
    s_lshl_b32 s49, s78, 5
    s_add_u32 s48, s48, s49
    s_mul_i32 s52, s48, 2560
    s_add_u32 s52, s52, 0x240000
    s_add_u32 s53, s52, 81920
    s_lshl_b32 s48, s68, 1
    s_add_u32 s48, s48, s77
    s_lshl_b32 s49, s47, 4
    s_add_u32 s48, s48, s49
    s_lshl_b32 s56, s48, 12
    s_lshr_b32 s49, s47, 1
    s_lshl_b32 s49, s49, 4
    s_add_u32 s49, s49, s51
    s_lshl_b32 s57, s49, 10
    s_and_b32 s49, s47, 1
    s_lshl_b32 s49, s49, 2
    s_add_u32 s57, s57, s49
    s_add_u32 s57, s57, 0x200000
    s_lshl_b32 s49, s45, 4
    s_add_u32 s49, s49, s46
    s_lshl_b32 s49, s49, 7
    s_add_u32 s49, s49, 0x1420000
    s_waitcnt lgkmcnt(0)
    v_readfirstlane_b32 s73, v250
    s_cmp_lg_u32 s67, 0
    s_cbranch_scc1 L_pidle
    s_barrier
    s_mul_i32 s50, s68, 10240
    s_add_u32 s50, s50, s52
    s_add_u32 s51, s50, 10240
    s_cmp_eq_u32 s51, s53
    s_cselect_b32 s51, s52, s51
    s_mov_b32 s54, 8
    v_mov_b32 v176, 0
    v_mov_b32 v177, 0
    v_mov_b32 v178, 0
    v_mov_b32 v179, 0
    v_mov_b32 v180, 0
    v_mov_b32 v181, 0
    v_mov_b32 v182, 0
    v_mov_b32 v183, 0
    v_mov_b32 v184, 0
    v_mov_b32 v185, 0
    v_mov_b32 v186, 0
    v_mov_b32 v187, 0
    v_mov_b32 v188, 0
    v_mov_b32 v189, 0
    v_mov_b32 v190, 0
    v_mov_b32 v191, 0
    v_mov_b32 v192, 0
    v_mov_b32 v193, 0
    v_mov_b32 v194, 0
    v_mov_b32 v195, 0
    v_mov_b32 v196, 0
    v_mov_b32 v197, 0
    v_mov_b32 v198, 0
    v_mov_b32 v199, 0
    v_mov_b32 v200, 0
    v_mov_b32 v201, 0
    v_mov_b32 v202, 0
    v_mov_b32 v203, 0
    v_mov_b32 v204, 0
    v_mov_b32 v205, 0
    v_mov_b32 v206, 0
    v_mov_b32 v207, 0
    v_mov_b32 v208, 0
    v_mov_b32 v209, 0
    v_mov_b32 v210, 0
    v_mov_b32 v211, 0
    v_mov_b32 v212, 0
    v_mov_b32 v213, 0
    v_mov_b32 v214, 0
    v_mov_b32 v215, 0
    v_mov_b32 v216, 0
    v_mov_b32 v217, 0
    v_mov_b32 v218, 0
    v_mov_b32 v219, 0
    v_mov_b32 v220, 0
    v_mov_b32 v221, 0
    v_mov_b32 v222, 0
    v_mov_b32 v223, 0
    v_mov_b32 v92, 0
    v_mov_b32 v93, 0
    v_mov_b32 v94, 0
    v_mov_b32 v95, 0
    s_waitcnt vmcnt(0)
    s_mov_b64 exec, 1
    ds_add_rtn_u32 v2, v246, v247 offset:0
    s_waitcnt lgkmcnt(0)
    v_readfirstlane_b32 s48, v2
    v_mov_b32 v2, s49
    v_mov_b32 v3, s73
    s_cmp_lg_u32 s48, 3
    s_cbranch_scc1 L_nsig15
    buffer_store_dword v3, v2, s[40:43], 0 offen sc1
L_nsig15:
    s_mov_b64 exec, -1
    s_barrier
    s_lshl_b32 s3, s96, 12
    s_add_u32 m0, s3, 65536
    s_add_u32 vcc_lo, s98, 640
    s_add_u32 vcc_hi, s99, 1105920
    buffer_load_dwordx4 v228, s[12:15], vcc_lo offen offset:0 lds
    buffer_load_dwordx4 v229, s[12:15], vcc_lo offen offset:1024 lds
    buffer_load_dwordx4 v230, s[12:15], vcc_lo offen offset:2048 lds
    buffer_load_dwordx4 v231, s[12:15], vcc_lo offen offset:3072 lds
    s_add_u32 m0, s3, 81920
    s_nop 0
    buffer_load_dwordx4 v232, s[16:19], vcc_hi offen offset:0 lds
    buffer_load_dwordx4 v233, s[16:19], vcc_hi offen offset:1024 lds
    buffer_load_dwordx4 v234, s[16:19], vcc_hi offen offset:2048 lds
    buffer_load_dwordx4 v235, s[16:19], vcc_hi offen offset:3072 lds
    v_mov_b32 v160, 0
    v_mov_b32 v161, 0
    v_mov_b32 v162, 0
    v_mov_b32 v163, 0
    v_mov_b32 v164, 0
    v_mov_b32 v165, 0
    v_mov_b32 v166, 0
    v_mov_b32 v167, 0
    v_mov_b32 v168, 0
    v_mov_b32 v169, 0
    v_mov_b32 v170, 0
    v_mov_b32 v171, 0
    v_mov_b32 v172, 0
    v_mov_b32 v173, 0
    v_mov_b32 v174, 0
    v_mov_b32 v175, 0
    v_mov_b32 v152, 0
    v_mov_b32 v153, 0
    v_mov_b32 v154, 0
    v_mov_b32 v155, 0
    s_barrier
    s_lshl_b32 s3, s96, 12
    s_add_u32 m0, s3, 98304
    s_add_u32 vcc_lo, s98, 768
    s_add_u32 vcc_hi, s99, 1327104
    buffer_load_dwordx4 v228, s[12:15], vcc_lo offen offset:0 lds
    buffer_load_dwordx4 v229, s[12:15], vcc_lo offen offset:1024 lds
    buffer_load_dwordx4 v230, s[12:15], vcc_lo offen offset:2048 lds
    buffer_load_dwordx4 v231, s[12:15], vcc_lo offen offset:3072 lds
    s_add_u32 m0, s3, 114688
    s_nop 0
    buffer_load_dwordx4 v232, s[16:19], vcc_hi offen offset:0 lds
    buffer_load_dwordx4 v233, s[16:19], vcc_hi offen offset:1024 lds
    buffer_load_dwordx4 v234, s[16:19], vcc_hi offen offset:2048 lds
    buffer_load_dwordx4 v235, s[16:19], vcc_hi offen offset:3072 lds
    s_waitcnt vmcnt(8)
    s_barrier
    s_lshl_b32 s3, s96, 12
    s_add_u32 m0, s3, 0
    s_add_u32 vcc_lo, s98, 896
    s_add_u32 vcc_hi, s99, 1548288
    buffer_load_dwordx4 v228, s[12:15], vcc_lo offen offset:0 lds
    buffer_load_dwordx4 v229, s[12:15], vcc_lo offen offset:1024 lds
    buffer_load_dwordx4 v230, s[12:15], vcc_lo offen offset:2048 lds
    buffer_load_dwordx4 v231, s[12:15], vcc_lo offen offset:3072 lds
    s_add_u32 m0, s3, 16384
    s_nop 0
    buffer_load_dwordx4 v232, s[16:19], vcc_hi offen offset:0 lds
    buffer_load_dwordx4 v233, s[16:19], vcc_hi offen offset:1024 lds
    buffer_load_dwordx4 v234, s[16:19], vcc_hi offen offset:2048 lds
    buffer_load_dwordx4 v235, s[16:19], vcc_hi offen offset:3072 lds
    s_lshr_b32 s74, s44, 2
    s_xor_b32 s74, s74, s77
    s_and_b32 s3, s72, 5
    s_cmp_eq_u32 s3, s77
    s_cselect_b32 s75, 1, 0
    s_or_b32 s69, s74, 4
    s_cmp_eq_u32 s3, s69
    s_cselect_b32 s69, 1, 0
    v_and_b32 v1, 31, v0
    v_lshrrev_b32 v2, 5, v0
    v_lshlrev_b32 v3, 2, v1
    v_lshl_add_u32 v251, v2, 9, v3
    s_lshl_b32 s49, s71, 1
    s_add_u32 s48, s74, s49
    s_lshl_b32 s48, s48, 5
    s_lshr_b32 s49, s44, 1
    s_lshl_b32 s49, s49, 3
    s_add_u32 s48, s48, s49
    s_lshl_b32 s64, s48, 10
    s_add_u32 s64, s64, 0x10c0000
    s_add_u32 s65, s64, 4096
    s_lshl_b32 s67, s48, 7
    s_add_u32 s67, s67, 0x12c0000
    s_lshl_b32 s48, s71, 5
    s_add_u32 s48, s48, s49
    v_and_b32 v3, 7, v0
    v_add_u32 v1, s48, v3
    v_lshlrev_b32 v1, 7, v1
    v_add_u32 v254, 0x1460000, v1
    s_and_b32 s48, s44, 6
    s_add_u32 s48, s48, s74
    s_mul_i32 s48, s48, 8704
    s_add_u32 s48, s48, 83968
    v_add_u32 v252, s48, v244
    s_mul_i32 s48, s71, 147456
    s_lshl_b32 s49, s72, 7
    s_add_u32 s100, s48, s49
    s_add_u32 s101, s100, 1152
    v_lshrrev_b32 v1, 3, v0
    s_lshl_b32 s48, s44, 3
    v_add_u32 v2, s48, v1
    v_mul_u32_u24 v2, 2304, v2
    v_lshl_add_u32 v255, v3, 4, v2
    v_mul_u32_u24 v3, 1088, v3
    v_lshl_add_u32 v3, v1, 4, v3
    s_lshr_b32 s48, s44, 2
    s_mul_i32 s48, s48, 8704
    s_lshl_b32 s49, s96, 7
    s_add_u32 s48, s48, s49
    v_add_u32 v253, s48, v3
    s_mul_i32 s48, s78, 18432
    s_add_u32 s48, s48, 83968
    s_mul_i32 s49, s78, 9216
    s_add_u32 s49, s49, 65536
    v_bfe_u32 v1, v0, 2, 2
    v_lshrrev_b32 v2, 5, v0
    v_and_b32 v3, 3, v0
    v_bfe_u32 v4, v0, 4, 1
    v_lshl_add_u32 v3, v4, 2, v3
    v_lshlrev_b32 v3, 3, v3
    v_lshl_add_u32 v1, v2, 2, v1
    v_lshl_add_u32 v240, v1, 6, v3
    v_add_u32 v240, s49, v240
    v_bfe_u32 v4, v0, 3, 1
    v_lshl_add_u32 v3, v4, 6, v3
    v_lshl_add_u32 v236, v1, 7, v3
    v_add_u32 v236, s48, v236
    v_xor_b32 v237, 64, v236
    v_mul_u32_u24 v2, 68, v2
    v_add_u32 v2, 16, v2
    v_lshl_add_u32 v238, v2, 7, v236
    v_lshl_add_u32 v239, v2, 7, v237
    v_lshl_add_u32 v241, v2, 6, v240
    s_mul_i32 s48, s44, 6144
    v_add_u32 v226, s48, v244
    s_xor_b32 s48, s44, 2
    s_mul_i32 s48, s48, 6144
    v_add_u32 v227, s48, v244
    s_lshl_b32 s48, s68, 2
    s_lshl_b32 s49, s77, 1
    s_add_u32 s48, s48, s49
    s_add_u32 s48, s48, s78
    s_lshl_b32 s49, s48, 5
    s_add_u32 s49, s49, s47
    s_lshl_b32 s49, s49, 7
    s_add_u32 s49, s49, 0x1460000
    v_mov_b32 v224, s49
    v_mov_b32 v225, s73
    s_lshl_b32 s48, s48, 1
    s_lshl_b32 s48, s48, 5
    s_add_u32 s48, s48, s47
    s_lshl_b32 s60, s48, 10
    s_add_u32 s60, s60, 0x10c0000
    s_add_u32 s61, s60, 0x8000
    s_lshl_b32 s62, s48, 7
    s_add_u32 s62, s62, 0x12c0000
    s_add_u32 s63, s62, 0x1000
    s_waitcnt vmcnt(8)
    s_barrier
    buffer_load_dword v2, v249, s[40:43], 0 offen sc1
    s_lshl_b32 s3, s96, 12
    s_add_u32 m0, s3, 32768
    s_add_u32 vcc_lo, s98, 1024
    s_add_u32 vcc_hi, s99, 1769472
    buffer_load_dwordx4 v228, s[12:15], vcc_lo offen offset:0 lds
    buffer_load_dwordx4 v229, s[12:15], vcc_lo offen offset:1024 lds
    buffer_load_dwordx4 v230, s[12:15], vcc_lo offen offset:2048 lds
    buffer_load_dwordx4 v231, s[12:15], vcc_lo offen offset:3072 lds
    s_add_u32 m0, s3, 49152
    s_nop 0
    buffer_load_dwordx4 v232, s[16:19], vcc_hi offen offset:0 lds
    buffer_load_dwordx4 v233, s[16:19], vcc_hi offen offset:1024 lds
    buffer_load_dwordx4 v234, s[16:19], vcc_hi offen offset:2048 lds
    buffer_load_dwordx4 v235, s[16:19], vcc_hi offen offset:3072 lds
    s_waitcnt vmcnt(8)
    v_cmp_ne_u32 vcc, s73, v2
    s_cbranch_vccnz L_late
    s_barrier
    buffer_load_dwordx4 v[16:19], v244, s[40:43], s56 offen offset:0 sc1
    buffer_load_dwordx4 v[20:23], v244, s[40:43], s56 offen offset:1024 sc1
    buffer_load_dwordx4 v[24:27], v244, s[40:43], s56 offen offset:2048 sc1
    buffer_load_dwordx4 v[28:31], v244, s[40:43], s56 offen offset:3072 sc1
    buffer_load_dword v32, v7, s[40:43], s57 offen offset:0 sc1
    buffer_load_dword v34, v7, s[40:43], s57 offen offset:512 sc1
    buffer_load_dwordx4 v[40:43], v8, s[40:43], s50 offen offset:0 sc1
    buffer_load_dword v56, v10, s[40:43], s50 offen sc1
    buffer_load_dwordx4 v[64:67], v12, s[40:43], s50 offen offset:0 sc1
    buffer_load_dwordx4 v[68:71], v14, s[40:43], s50 offen offset:0 sc1
    buffer_load_dwordx4 v[44:47], v8, s[40:43], s50 offen offset:2560 sc1
    buffer_load_dwordx4 v[72:75], v12, s[40:43], s50 offen offset:2560 sc1
    buffer_load_dwordx4 v[76:79], v14, s[40:43], s50 offen offset:2560 sc1
    buffer_load_dwordx4 v[48:51], v9, s[40:43], s50 offen offset:0 sc1
    buffer_load_dword v58, v11, s[40:43], s50 offen sc1
    buffer_load_dwordx4 v[80:83], v13, s[40:43], s50 offen offset:0 sc1
    buffer_load_dwordx4 v[84:87], v15, s[40:43], s50 offen offset:0 sc1
    s_waitcnt vmcnt(17)
    s_barrier
    s_branch L_go
L_late:
    s_barrier
    s_waitcnt vmcnt(0)
    s_barrier
    s_branch L_poll
L_pidle:
    s_mul_i32 s50, s68, 10240
    s_add_u32 s50, s50, s52
    s_add_u32 s51, s50, 10240
    s_cmp_eq_u32 s51, s53
    s_cselect_b32 s51, s52, s51
    s_mov_b32 s54, 8
    v_mov_b32 v176, 0
    v_mov_b32 v177, 0
    v_mov_b32 v178, 0
    v_mov_b32 v179, 0
    v_mov_b32 v180, 0
    v_mov_b32 v181, 0
    v_mov_b32 v182, 0
    v_mov_b32 v183, 0
    v_mov_b32 v184, 0
    v_mov_b32 v185, 0
    v_mov_b32 v186, 0
    v_mov_b32 v187, 0
    v_mov_b32 v188, 0
    v_mov_b32 v189, 0
    v_mov_b32 v190, 0
    v_mov_b32 v191, 0
    v_mov_b32 v192, 0
    v_mov_b32 v193, 0
    v_mov_b32 v194, 0
    v_mov_b32 v195, 0
    v_mov_b32 v196, 0
    v_mov_b32 v197, 0
    v_mov_b32 v198, 0
    v_mov_b32 v199, 0
    v_mov_b32 v200, 0
    v_mov_b32 v201, 0
    v_mov_b32 v202, 0
    v_mov_b32 v203, 0
    v_mov_b32 v204, 0
    v_mov_b32 v205, 0
    v_mov_b32 v206, 0
    v_mov_b32 v207, 0
    v_mov_b32 v208, 0
    v_mov_b32 v209, 0
    v_mov_b32 v210, 0
    v_mov_b32 v211, 0
    v_mov_b32 v212, 0
    v_mov_b32 v213, 0
    v_mov_b32 v214, 0
    v_mov_b32 v215, 0
    v_mov_b32 v216, 0
    v_mov_b32 v217, 0
    v_mov_b32 v218, 0
    v_mov_b32 v219, 0
    v_mov_b32 v220, 0
    v_mov_b32 v221, 0
    v_mov_b32 v222, 0
    v_mov_b32 v223, 0
    v_mov_b32 v92, 0
    v_mov_b32 v93, 0
    v_mov_b32 v94, 0
    v_mov_b32 v95, 0
    v_mov_b32 v160, 0
    v_mov_b32 v161, 0
    v_mov_b32 v162, 0
    v_mov_b32 v163, 0
    v_mov_b32 v164, 0
    v_mov_b32 v165, 0
    v_mov_b32 v166, 0
    v_mov_b32 v167, 0
    v_mov_b32 v168, 0
    v_mov_b32 v169, 0
    v_mov_b32 v170, 0
    v_mov_b32 v171, 0
    v_mov_b32 v172, 0
    v_mov_b32 v173, 0
    v_mov_b32 v174, 0
    v_mov_b32 v175, 0
    v_mov_b32 v152, 0
    v_mov_b32 v153, 0
    v_mov_b32 v154, 0
    v_mov_b32 v155, 0
    s_lshr_b32 s74, s44, 2
    s_xor_b32 s74, s74, s77
    s_and_b32 s3, s72, 5
    s_cmp_eq_u32 s3, s77
    s_cselect_b32 s75, 1, 0
    s_or_b32 s69, s74, 4
    s_cmp_eq_u32 s3, s69
    s_cselect_b32 s69, 1, 0
    v_and_b32 v1, 31, v0
    v_lshrrev_b32 v2, 5, v0
    v_lshlrev_b32 v3, 2, v1
    v_lshl_add_u32 v251, v2, 9, v3
    s_lshl_b32 s49, s71, 1
    s_add_u32 s48, s74, s49
    s_lshl_b32 s48, s48, 5
    s_lshr_b32 s49, s44, 1
    s_lshl_b32 s49, s49, 3
    s_add_u32 s48, s48, s49
    s_lshl_b32 s64, s48, 10
    s_add_u32 s64, s64, 0x10c0000
    s_add_u32 s65, s64, 4096
    s_lshl_b32 s67, s48, 7
    s_add_u32 s67, s67, 0x12c0000
    s_lshl_b32 s48, s71, 5
    s_add_u32 s48, s48, s49
    v_and_b32 v3, 7, v0
    v_add_u32 v1, s48, v3
    v_lshlrev_b32 v1, 7, v1
    v_add_u32 v254, 0x1460000, v1
    s_and_b32 s48, s44, 6
    s_add_u32 s48, s48, s74
    s_mul_i32 s48, s48, 8704
    s_add_u32 s48, s48, 83968
    v_add_u32 v252, s48, v244
    s_mul_i32 s48, s71, 147456
    s_lshl_b32 s49, s72, 7
    s_add_u32 s100, s48, s49
    s_add_u32 s101, s100, 1152
    v_lshrrev_b32 v1, 3, v0
    s_lshl_b32 s48, s44, 3
    v_add_u32 v2, s48, v1
    v_mul_u32_u24 v2, 2304, v2
    v_lshl_add_u32 v255, v3, 4, v2
    v_mul_u32_u24 v3, 1088, v3
    v_lshl_add_u32 v3, v1, 4, v3
    s_lshr_b32 s48, s44, 2
    s_mul_i32 s48, s48, 8704
    s_lshl_b32 s49, s96, 7
    s_add_u32 s48, s48, s49
    v_add_u32 v253, s48, v3
    s_mul_i32 s48, s78, 18432
    s_add_u32 s48, s48, 83968
    s_mul_i32 s49, s78, 9216
    s_add_u32 s49, s49, 65536
    v_bfe_u32 v1, v0, 2, 2
    v_lshrrev_b32 v2, 5, v0
    v_and_b32 v3, 3, v0
    v_bfe_u32 v4, v0, 4, 1
    v_lshl_add_u32 v3, v4, 2, v3
    v_lshlrev_b32 v3, 3, v3
    v_lshl_add_u32 v1, v2, 2, v1
    v_lshl_add_u32 v240, v1, 6, v3
    v_add_u32 v240, s49, v240
    v_bfe_u32 v4, v0, 3, 1
    v_lshl_add_u32 v3, v4, 6, v3
    v_lshl_add_u32 v236, v1, 7, v3
    v_add_u32 v236, s48, v236
    v_xor_b32 v237, 64, v236
    v_mul_u32_u24 v2, 68, v2
    v_add_u32 v2, 16, v2
    v_lshl_add_u32 v238, v2, 7, v236
    v_lshl_add_u32 v239, v2, 7, v237
    v_lshl_add_u32 v241, v2, 6, v240
    s_mul_i32 s48, s44, 6144
    v_add_u32 v226, s48, v244
    s_xor_b32 s48, s44, 2
    s_mul_i32 s48, s48, 6144
    v_add_u32 v227, s48, v244
    s_lshl_b32 s48, s68, 2
    s_lshl_b32 s49, s77, 1
    s_add_u32 s48, s48, s49
    s_add_u32 s48, s48, s78
    s_lshl_b32 s49, s48, 5
    s_add_u32 s49, s49, s47
    s_lshl_b32 s49, s49, 7
    s_add_u32 s49, s49, 0x1460000
    v_mov_b32 v224, s49
    v_mov_b32 v225, s73
    s_lshl_b32 s48, s48, 1
    s_lshl_b32 s48, s48, 5
    s_add_u32 s48, s48, s47
    s_lshl_b32 s60, s48, 10
    s_add_u32 s60, s60, 0x10c0000
    s_add_u32 s61, s60, 0x8000
    s_lshl_b32 s62, s48, 7
    s_add_u32 s62, s62, 0x12c0000
    s_add_u32 s63, s62, 0x1000
L_poll:
L_poll16:
    buffer_load_dword v2, v249, s[40:43], 0 offen sc1
    s_waitcnt vmcnt(0)
L_pollc18:
    v_cmp_ne_u32 vcc, s73, v2
    s_cbranch_vccz L_polld17
    s_sleep 1
    s_sub_u32 s76, s76, 1
    s_cbranch_scc0 L_poll16
    s_endpgm
L_polld17:
    buffer_load_dwordx4 v[16:19], v244, s[40:43], s56 offen offset:0 sc1
    buffer_load_dwordx4 v[20:23], v244, s[40:43], s56 offen offset:1024 sc1
    buffer_load_dwordx4 v[24:27], v244, s[40:43], s56 offen offset:2048 sc1
    buffer_load_dwordx4 v[28:31], v244, s[40:43], s56 offen offset:3072 sc1
    buffer_load_dword v32, v7, s[40:43], s57 offen offset:0 sc1
    buffer_load_dword v34, v7, s[40:43], s57 offen offset:512 sc1
    buffer_load_dwordx4 v[40:43], v8, s[40:43], s50 offen offset:0 sc1
    buffer_load_dword v56, v10, s[40:43], s50 offen sc1
    buffer_load_dwordx4 v[64:67], v12, s[40:43], s50 offen offset:0 sc1
    buffer_load_dwordx4 v[68:71], v14, s[40:43], s50 offen offset:0 sc1
    buffer_load_dwordx4 v[44:47], v8, s[40:43], s50 offen offset:2560 sc1
    buffer_load_dwordx4 v[72:75], v12, s[40:43], s50 offen offset:2560 sc1
    buffer_load_dwordx4 v[76:79], v14, s[40:43], s50 offen offset:2560 sc1
    buffer_load_dwordx4 v[48:51], v9, s[40:43], s50 offen offset:0 sc1
    buffer_load_dword v58, v11, s[40:43], s50 offen sc1
    buffer_load_dwordx4 v[80:83], v13, s[40:43], s50 offen offset:0 sc1
    buffer_load_dwordx4 v[84:87], v15, s[40:43], s50 offen offset:0 sc1
L_go:
    s_mov_b32 s59, 0x07060302
    s_waitcnt vmcnt(7)
    v_mfma_f32_32x32x4_2b_bf16 v[96:127], v[56:57], v[32:33], 0 cbsz:1 abid:0
    s_nop 15
    s_nop 1
    v_mfma_f32_32x32x16_bf16 v[96:111], v[40:43], v[16:19], v[96:111]
    v_mfma_f32_32x32x16_bf16 v[112:127], v[40:43], v[20:23], v[112:127]
    s_nop 9
    s_setprio 0
    .p2align 6
L_attn:
    v_exp_f32 v96, v96
    v_exp_f32 v97, v97
    v_mfma_f32_32x32x16_bf16 v[208:223], v[92:95], v[152:155], v[208:223]
    v_exp_f32 v98, v98
    v_exp_f32 v99, v99
    v_exp_f32 v100, v100
    v_exp_f32 v101, v101
    v_mfma_f32_32x32x4_2b_bf16 v[128:159], v[56:57], v[34:35], 0 cbsz:1 abid:0
    buffer_load_dwordx4 v[52:55], v9, s[40:43], s50 offen offset:2560 sc1
    buffer_load_dwordx4 v[88:91], v13, s[40:43], s50 offen offset:2560 sc1
    buffer_load_dwordx4 v[92:95], v15, s[40:43], s50 offen offset:2560 sc1
    v_exp_f32 v102, v102
    v_exp_f32 v103, v103
    v_exp_f32 v104, v104
    v_cvt_pk_bf16_f32 v96, v96, v97
    v_cvt_pk_bf16_f32 v97, v98, v99
    v_cvt_pk_bf16_f32 v98, v100, v101
    v_cvt_pk_bf16_f32 v99, v102, v103
    v_exp_f32 v105, v105
    v_exp_f32 v106, v106
    v_exp_f32 v107, v107
    v_mfma_f32_32x32x16_bf16 v[160:175], v[64:67], v[96:99], v[160:175]
    v_exp_f32 v108, v108
    v_exp_f32 v109, v109
    v_exp_f32 v110, v110
    v_exp_f32 v111, v111
    v_exp_f32 v112, v112
    v_cvt_pk_bf16_f32 v104, v104, v105
    v_cvt_pk_bf16_f32 v105, v106, v107
    v_mfma_f32_32x32x16_bf16 v[128:143], v[40:43], v[24:27], v[128:143]
    v_cvt_pk_bf16_f32 v106, v108, v109
    v_cvt_pk_bf16_f32 v107, v110, v111
    v_exp_f32 v113, v113
    v_exp_f32 v114, v114
    v_exp_f32 v115, v115
    v_mfma_f32_32x32x16_bf16 v[160:175], v[68:71], v[104:107], v[160:175]
    v_exp_f32 v116, v116
    v_exp_f32 v117, v117
    v_exp_f32 v118, v118
    v_exp_f32 v119, v119
    v_exp_f32 v120, v120
    v_cvt_pk_bf16_f32 v112, v112, v113
    v_cvt_pk_bf16_f32 v113, v114, v115
    v_mfma_f32_32x32x16_bf16 v[144:159], v[40:43], v[28:31], v[144:159]
    v_cvt_pk_bf16_f32 v114, v116, v117
    v_cvt_pk_bf16_f32 v115, v118, v119
    v_exp_f32 v121, v121
    v_exp_f32 v122, v122
    v_exp_f32 v123, v123
    v_mfma_f32_32x32x16_bf16 v[176:191], v[64:67], v[112:115], v[176:191]
    v_exp_f32 v124, v124
    v_exp_f32 v125, v125
    v_exp_f32 v126, v126
    v_exp_f32 v127, v127
    v_cvt_pk_bf16_f32 v120, v120, v121
    v_cvt_pk_bf16_f32 v121, v122, v123
    v_cvt_pk_bf16_f32 v122, v124, v125
    v_cvt_pk_bf16_f32 v123, v126, v127
    v_exp_f32 v128, v128
    v_exp_f32 v129, v129
    v_mfma_f32_32x32x16_bf16 v[176:191], v[68:71], v[120:123], v[176:191]
    s_waitcnt vmcnt(7)
    v_exp_f32 v130, v130
    v_exp_f32 v131, v131
    v_exp_f32 v132, v132
    v_exp_f32 v133, v133
    v_mfma_f32_32x32x4_2b_bf16 v[96:127], v[56:57], v[32:33], 0 cbsz:1 abid:1
    v_exp_f32 v134, v134
    v_exp_f32 v135, v135
    v_exp_f32 v136, v136
    v_cvt_pk_bf16_f32 v128, v128, v129
    v_cvt_pk_bf16_f32 v129, v130, v131
    v_cvt_pk_bf16_f32 v130, v132, v133
    v_cvt_pk_bf16_f32 v131, v134, v135
    v_exp_f32 v137, v137
    v_exp_f32 v138, v138
    v_exp_f32 v139, v139
    v_mfma_f32_32x32x16_bf16 v[192:207], v[64:67], v[128:131], v[192:207]
    v_exp_f32 v140, v140
    v_exp_f32 v141, v141
    v_exp_f32 v142, v142
    v_exp_f32 v143, v143
    v_exp_f32 v144, v144
    v_cvt_pk_bf16_f32 v136, v136, v137
    v_cvt_pk_bf16_f32 v137, v138, v139
    v_mfma_f32_32x32x16_bf16 v[96:111], v[44:47], v[16:19], v[96:111]
    v_cvt_pk_bf16_f32 v138, v140, v141
    v_cvt_pk_bf16_f32 v139, v142, v143
    v_exp_f32 v145, v145
    v_exp_f32 v146, v146
    v_exp_f32 v147, v147
    v_mfma_f32_32x32x16_bf16 v[192:207], v[68:71], v[136:139], v[192:207]
    v_exp_f32 v148, v148
    v_exp_f32 v149, v149
    v_exp_f32 v150, v150
    v_exp_f32 v151, v151
    v_exp_f32 v152, v152
    v_cvt_pk_bf16_f32 v144, v144, v145
    v_cvt_pk_bf16_f32 v145, v146, v147
    v_mfma_f32_32x32x16_bf16 v[112:127], v[44:47], v[20:23], v[112:127]
    v_cvt_pk_bf16_f32 v146, v148, v149
    v_cvt_pk_bf16_f32 v147, v150, v151
    v_exp_f32 v153, v153
    v_exp_f32 v154, v154
    v_exp_f32 v155, v155
    v_mfma_f32_32x32x16_bf16 v[208:223], v[64:67], v[144:147], v[208:223]
    v_exp_f32 v156, v156
    v_exp_f32 v157, v157
    v_exp_f32 v158, v158
    v_exp_f32 v159, v159
    v_cvt_pk_bf16_f32 v152, v152, v153
    v_cvt_pk_bf16_f32 v153, v154, v155
    v_cvt_pk_bf16_f32 v154, v156, v157
    v_cvt_pk_bf16_f32 v155, v158, v159
    v_exp_f32 v96, v96
    v_exp_f32 v97, v97
    v_mfma_f32_32x32x16_bf16 v[208:223], v[68:71], v[152:155], v[208:223]
    v_exp_f32 v98, v98
    v_exp_f32 v99, v99
    v_exp_f32 v100, v100
    v_exp_f32 v101, v101
    v_mfma_f32_32x32x4_2b_bf16 v[128:159], v[56:57], v[34:35], 0 cbsz:1 abid:1
    buffer_load_dwordx4 v[40:43], v8, s[40:43], s51 offen offset:0 sc1
    buffer_load_dword v56, v10, s[40:43], s51 offen sc1
    buffer_load_dwordx4 v[64:67], v12, s[40:43], s51 offen offset:0 sc1
    buffer_load_dwordx4 v[68:71], v14, s[40:43], s51 offen offset:0 sc1
    v_exp_f32 v102, v102
    v_exp_f32 v103, v103
    v_exp_f32 v104, v104
    v_cvt_pk_bf16_f32 v96, v96, v97
    v_cvt_pk_bf16_f32 v97, v98, v99
    v_cvt_pk_bf16_f32 v98, v100, v101
    v_cvt_pk_bf16_f32 v99, v102, v103
    v_exp_f32 v105, v105
    v_exp_f32 v106, v106
    v_exp_f32 v107, v107
    v_mfma_f32_32x32x16_bf16 v[160:175], v[72:75], v[96:99], v[160:175]
    v_exp_f32 v108, v108
    v_exp_f32 v109, v109
    v_exp_f32 v110, v110
    v_exp_f32 v111, v111
    v_exp_f32 v112, v112
    v_cvt_pk_bf16_f32 v104, v104, v105
    v_cvt_pk_bf16_f32 v105, v106, v107
    v_mfma_f32_32x32x16_bf16 v[128:143], v[44:47], v[24:27], v[128:143]
    v_cvt_pk_bf16_f32 v106, v108, v109
    v_cvt_pk_bf16_f32 v107, v110, v111
    v_exp_f32 v113, v113
    v_exp_f32 v114, v114
    v_exp_f32 v115, v115
    v_mfma_f32_32x32x16_bf16 v[160:175], v[76:79], v[104:107], v[160:175]
    v_exp_f32 v116, v116
    v_exp_f32 v117, v117
    v_exp_f32 v118, v118
    v_exp_f32 v119, v119
    v_exp_f32 v120, v120
    v_cvt_pk_bf16_f32 v112, v112, v113
    v_cvt_pk_bf16_f32 v113, v114, v115
    v_mfma_f32_32x32x16_bf16 v[144:159], v[44:47], v[28:31], v[144:159]
    v_cvt_pk_bf16_f32 v114, v116, v117
    v_cvt_pk_bf16_f32 v115, v118, v119
    v_exp_f32 v121, v121
    v_exp_f32 v122, v122
    v_exp_f32 v123, v123
    v_mfma_f32_32x32x16_bf16 v[176:191], v[72:75], v[112:115], v[176:191]
    v_exp_f32 v124, v124
    v_exp_f32 v125, v125
    v_exp_f32 v126, v126
    v_exp_f32 v127, v127
    v_cvt_pk_bf16_f32 v120, v120, v121
    v_cvt_pk_bf16_f32 v121, v122, v123
    v_cvt_pk_bf16_f32 v122, v124, v125
    v_cvt_pk_bf16_f32 v123, v126, v127
    v_exp_f32 v128, v128
    v_exp_f32 v129, v129
    v_mfma_f32_32x32x16_bf16 v[176:191], v[76:79], v[120:123], v[176:191]
    s_waitcnt vmcnt(7)
    v_exp_f32 v130, v130
    v_exp_f32 v131, v131
    v_exp_f32 v132, v132
    v_exp_f32 v133, v133
    v_mfma_f32_32x32x4_2b_bf16 v[96:127], v[58:59], v[32:33], 0 cbsz:1 abid:0
    v_exp_f32 v134, v134
    v_exp_f32 v135, v135
    v_exp_f32 v136, v136
    v_cvt_pk_bf16_f32 v128, v128, v129
    v_cvt_pk_bf16_f32 v129, v130, v131
    v_cvt_pk_bf16_f32 v130, v132, v133
    v_cvt_pk_bf16_f32 v131, v134, v135
    v_exp_f32 v137, v137
    v_exp_f32 v138, v138
    v_exp_f32 v139, v139
    v_mfma_f32_32x32x16_bf16 v[192:207], v[72:75], v[128:131], v[192:207]
    v_exp_f32 v140, v140
    v_exp_f32 v141, v141
    v_exp_f32 v142, v142
    v_exp_f32 v143, v143
    v_exp_f32 v144, v144
    v_cvt_pk_bf16_f32 v136, v136, v137
    v_cvt_pk_bf16_f32 v137, v138, v139
    v_mfma_f32_32x32x16_bf16 v[96:111], v[48:51], v[16:19], v[96:111]
    v_cvt_pk_bf16_f32 v138, v140, v141
    v_cvt_pk_bf16_f32 v139, v142, v143
    v_exp_f32 v145, v145
    v_exp_f32 v146, v146
    v_exp_f32 v147, v147
    v_mfma_f32_32x32x16_bf16 v[192:207], v[76:79], v[136:139], v[192:207]
    v_exp_f32 v148, v148
    v_exp_f32 v149, v149
    v_exp_f32 v150, v150
    v_exp_f32 v151, v151
    v_exp_f32 v152, v152
    v_cvt_pk_bf16_f32 v144, v144, v145
    v_cvt_pk_bf16_f32 v145, v146, v147
    v_mfma_f32_32x32x16_bf16 v[112:127], v[48:51], v[20:23], v[112:127]
    v_cvt_pk_bf16_f32 v146, v148, v149
    v_cvt_pk_bf16_f32 v147, v150, v151
    v_exp_f32 v153, v153
    v_exp_f32 v154, v154
    v_exp_f32 v155, v155
    v_mfma_f32_32x32x16_bf16 v[208:223], v[72:75], v[144:147], v[208:223]
    v_exp_f32 v156, v156
    v_exp_f32 v157, v157
    v_exp_f32 v158, v158
    v_exp_f32 v159, v159
    v_cvt_pk_bf16_f32 v152, v152, v153
    v_cvt_pk_bf16_f32 v153, v154, v155
    v_cvt_pk_bf16_f32 v154, v156, v157
    v_cvt_pk_bf16_f32 v155, v158, v159
    v_exp_f32 v96, v96
    v_exp_f32 v97, v97
    v_mfma_f32_32x32x16_bf16 v[208:223], v[76:79], v[152:155], v[208:223]
    v_exp_f32 v98, v98
    v_exp_f32 v99, v99
    v_exp_f32 v100, v100
    v_exp_f32 v101, v101
    v_mfma_f32_32x32x4_2b_bf16 v[128:159], v[58:59], v[34:35], 0 cbsz:1 abid:0
    buffer_load_dwordx4 v[44:47], v8, s[40:43], s51 offen offset:2560 sc1
    buffer_load_dwordx4 v[72:75], v12, s[40:43], s51 offen offset:2560 sc1
    buffer_load_dwordx4 v[76:79], v14, s[40:43], s51 offen offset:2560 sc1
    v_exp_f32 v102, v102
    v_exp_f32 v103, v103
    v_exp_f32 v104, v104
    v_cvt_pk_bf16_f32 v96, v96, v97
    v_cvt_pk_bf16_f32 v97, v98, v99
    v_cvt_pk_bf16_f32 v98, v100, v101
    v_cvt_pk_bf16_f32 v99, v102, v103
    v_exp_f32 v105, v105
    v_exp_f32 v106, v106
    v_exp_f32 v107, v107
    v_mfma_f32_32x32x16_bf16 v[160:175], v[80:83], v[96:99], v[160:175]
    v_exp_f32 v108, v108
    v_exp_f32 v109, v109
    v_exp_f32 v110, v110
    v_exp_f32 v111, v111
    v_exp_f32 v112, v112
    v_cvt_pk_bf16_f32 v104, v104, v105
    v_cvt_pk_bf16_f32 v105, v106, v107
    v_mfma_f32_32x32x16_bf16 v[128:143], v[48:51], v[24:27], v[128:143]
    v_cvt_pk_bf16_f32 v106, v108, v109
    v_cvt_pk_bf16_f32 v107, v110, v111
    v_exp_f32 v113, v113
    v_exp_f32 v114, v114
    v_exp_f32 v115, v115
    v_mfma_f32_32x32x16_bf16 v[160:175], v[84:87], v[104:107], v[160:175]
    v_exp_f32 v116, v116
    v_exp_f32 v117, v117
    v_exp_f32 v118, v118
    v_exp_f32 v119, v119
    v_exp_f32 v120, v120
    v_cvt_pk_bf16_f32 v112, v112, v113
    v_cvt_pk_bf16_f32 v113, v114, v115
    v_mfma_f32_32x32x16_bf16 v[144:159], v[48:51], v[28:31], v[144:159]
    v_cvt_pk_bf16_f32 v114, v116, v117
    v_cvt_pk_bf16_f32 v115, v118, v119
    v_exp_f32 v121, v121
    v_exp_f32 v122, v122
    v_exp_f32 v123, v123
    v_mfma_f32_32x32x16_bf16 v[176:191], v[80:83], v[112:115], v[176:191]
    v_exp_f32 v124, v124
    v_exp_f32 v125, v125
    v_exp_f32 v126, v126
    v_exp_f32 v127, v127
    v_cvt_pk_bf16_f32 v120, v120, v121
    v_cvt_pk_bf16_f32 v121, v122, v123
    v_cvt_pk_bf16_f32 v122, v124, v125
    v_cvt_pk_bf16_f32 v123, v126, v127
    v_exp_f32 v128, v128
    v_exp_f32 v129, v129
    v_mfma_f32_32x32x16_bf16 v[176:191], v[84:87], v[120:123], v[176:191]
    s_waitcnt vmcnt(7)
    v_exp_f32 v130, v130
    v_exp_f32 v131, v131
    v_exp_f32 v132, v132
    v_exp_f32 v133, v133
    v_mfma_f32_32x32x4_2b_bf16 v[96:127], v[58:59], v[32:33], 0 cbsz:1 abid:1
    v_exp_f32 v134, v134
    v_exp_f32 v135, v135
    v_exp_f32 v136, v136
    v_cvt_pk_bf16_f32 v128, v128, v129
    v_cvt_pk_bf16_f32 v129, v130, v131
    v_cvt_pk_bf16_f32 v130, v132, v133
    v_cvt_pk_bf16_f32 v131, v134, v135
    v_exp_f32 v137, v137
    v_exp_f32 v138, v138
    v_exp_f32 v139, v139
    v_mfma_f32_32x32x16_bf16 v[192:207], v[80:83], v[128:131], v[192:207]
    v_exp_f32 v140, v140
    v_exp_f32 v141, v141
    v_exp_f32 v142, v142
    v_exp_f32 v143, v143
    v_exp_f32 v144, v144
    v_cvt_pk_bf16_f32 v136, v136, v137
    v_cvt_pk_bf16_f32 v137, v138, v139
    v_mfma_f32_32x32x16_bf16 v[96:111], v[52:55], v[16:19], v[96:111]
    v_cvt_pk_bf16_f32 v138, v140, v141
    v_cvt_pk_bf16_f32 v139, v142, v143
    v_exp_f32 v145, v145
    v_exp_f32 v146, v146
    v_exp_f32 v147, v147
    v_mfma_f32_32x32x16_bf16 v[192:207], v[84:87], v[136:139], v[192:207]
    v_exp_f32 v148, v148
    v_exp_f32 v149, v149
    v_exp_f32 v150, v150
    v_exp_f32 v151, v151
    v_exp_f32 v152, v152
    v_cvt_pk_bf16_f32 v144, v144, v145
    v_cvt_pk_bf16_f32 v145, v146, v147
    v_mfma_f32_32x32x16_bf16 v[112:127], v[52:55], v[20:23], v[112:127]
    v_cvt_pk_bf16_f32 v146, v148, v149
    v_cvt_pk_bf16_f32 v147, v150, v151
    v_exp_f32 v153, v153
    v_exp_f32 v154, v154
    v_exp_f32 v155, v155
    v_mfma_f32_32x32x16_bf16 v[208:223], v[80:83], v[144:147], v[208:223]
    v_exp_f32 v156, v156
    v_exp_f32 v157, v157
    v_exp_f32 v158, v158
    v_exp_f32 v159, v159
    v_cvt_pk_bf16_f32 v152, v152, v153
    v_cvt_pk_bf16_f32 v153, v154, v155
    v_cvt_pk_bf16_f32 v154, v156, v157
    v_cvt_pk_bf16_f32 v155, v158, v159
    v_exp_f32 v96, v96
    v_exp_f32 v97, v97
    v_mfma_f32_32x32x16_bf16 v[208:223], v[84:87], v[152:155], v[208:223]
    v_exp_f32 v98, v98
    v_exp_f32 v99, v99
    v_exp_f32 v100, v100
    v_exp_f32 v101, v101
    v_mfma_f32_32x32x4_2b_bf16 v[128:159], v[58:59], v[34:35], 0 cbsz:1 abid:1
    buffer_load_dwordx4 v[48:51], v9, s[40:43], s51 offen offset:0 sc1
    buffer_load_dword v58, v11, s[40:43], s51 offen sc1
    buffer_load_dwordx4 v[80:83], v13, s[40:43], s51 offen offset:0 sc1
    buffer_load_dwordx4 v[84:87], v15, s[40:43], s51 offen offset:0 sc1
    v_exp_f32 v102, v102
    v_exp_f32 v103, v103
    v_exp_f32 v104, v104
    v_cvt_pk_bf16_f32 v96, v96, v97
    v_cvt_pk_bf16_f32 v97, v98, v99
    v_cvt_pk_bf16_f32 v98, v100, v101
    v_cvt_pk_bf16_f32 v99, v102, v103
    v_exp_f32 v105, v105
    v_exp_f32 v106, v106
    v_exp_f32 v107, v107
    v_mfma_f32_32x32x16_bf16 v[160:175], v[88:91], v[96:99], v[160:175]
    v_exp_f32 v108, v108
    v_exp_f32 v109, v109
    v_exp_f32 v110, v110
    v_exp_f32 v111, v111
    v_exp_f32 v112, v112
    v_cvt_pk_bf16_f32 v104, v104, v105
    v_cvt_pk_bf16_f32 v105, v106, v107
    v_mfma_f32_32x32x16_bf16 v[128:143], v[52:55], v[24:27], v[128:143]
    v_cvt_pk_bf16_f32 v106, v108, v109
    v_cvt_pk_bf16_f32 v107, v110, v111
    v_exp_f32 v113, v113
    v_exp_f32 v114, v114
    v_exp_f32 v115, v115
    v_mfma_f32_32x32x16_bf16 v[160:175], v[92:95], v[104:107], v[160:175]
    v_exp_f32 v116, v116
    v_exp_f32 v117, v117
    v_exp_f32 v118, v118
    v_exp_f32 v119, v119
    v_exp_f32 v120, v120
    v_cvt_pk_bf16_f32 v112, v112, v113
    v_cvt_pk_bf16_f32 v113, v114, v115
    v_mfma_f32_32x32x16_bf16 v[144:159], v[52:55], v[28:31], v[144:159]
    v_cvt_pk_bf16_f32 v114, v116, v117
    v_cvt_pk_bf16_f32 v115, v118, v119
    v_exp_f32 v121, v121
    v_exp_f32 v122, v122
    v_exp_f32 v123, v123
    v_mfma_f32_32x32x16_bf16 v[176:191], v[88:91], v[112:115], v[176:191]
    v_exp_f32 v124, v124
    v_exp_f32 v125, v125
    v_exp_f32 v126, v126
    v_exp_f32 v127, v127
    v_cvt_pk_bf16_f32 v120, v120, v121
    v_cvt_pk_bf16_f32 v121, v122, v123
    v_cvt_pk_bf16_f32 v122, v124, v125
    v_cvt_pk_bf16_f32 v123, v126, v127
    v_exp_f32 v128, v128
    v_exp_f32 v129, v129
    v_mfma_f32_32x32x16_bf16 v[176:191], v[92:95], v[120:123], v[176:191]
    s_waitcnt vmcnt(7)
    v_exp_f32 v130, v130
    v_exp_f32 v131, v131
    v_exp_f32 v132, v132
    v_exp_f32 v133, v133
    v_mfma_f32_32x32x4_2b_bf16 v[96:127], v[56:57], v[32:33], 0 cbsz:1 abid:0
    v_exp_f32 v134, v134
    v_exp_f32 v135, v135
    v_exp_f32 v136, v136
    v_cvt_pk_bf16_f32 v128, v128, v129
    v_cvt_pk_bf16_f32 v129, v130, v131
    v_cvt_pk_bf16_f32 v130, v132, v133
    v_cvt_pk_bf16_f32 v131, v134, v135
    v_exp_f32 v137, v137
    v_exp_f32 v138, v138
    v_exp_f32 v139, v139
    v_mfma_f32_32x32x16_bf16 v[192:207], v[88:91], v[128:131], v[192:207]
    v_exp_f32 v140, v140
    v_exp_f32 v141, v141
    v_exp_f32 v142, v142
    v_exp_f32 v143, v143
    v_exp_f32 v144, v144
    v_cvt_pk_bf16_f32 v136, v136, v137
    v_cvt_pk_bf16_f32 v137, v138, v139
    v_mfma_f32_32x32x16_bf16 v[96:111], v[40:43], v[16:19], v[96:111]
    v_cvt_pk_bf16_f32 v138, v140, v141
    v_cvt_pk_bf16_f32 v139, v142, v143
    v_exp_f32 v145, v145
    v_exp_f32 v146, v146
    v_exp_f32 v147, v147
    v_mfma_f32_32x32x16_bf16 v[192:207], v[92:95], v[136:139], v[192:207]
    v_exp_f32 v148, v148
    v_exp_f32 v149, v149
    v_exp_f32 v150, v150
    v_exp_f32 v151, v151
    v_exp_f32 v152, v152
    v_cvt_pk_bf16_f32 v144, v144, v145
    v_cvt_pk_bf16_f32 v145, v146, v147
    v_mfma_f32_32x32x16_bf16 v[112:127], v[40:43], v[20:23], v[112:127]
    s_mov_b32 s50, s51
    s_add_u32 s51, s51, 10240
    s_cmp_eq_u32 s51, s53
    s_cselect_b32 s51, s52, s51
    s_cmp_eq_u32 s54, 2
    s_cselect_b32 s51, 0x40000000, s51
    v_cvt_pk_bf16_f32 v146, v148, v149
    v_cvt_pk_bf16_f32 v147, v150, v151
    v_exp_f32 v153, v153
    v_exp_f32 v154, v154
    v_exp_f32 v155, v155
    v_mfma_f32_32x32x16_bf16 v[208:223], v[88:91], v[144:147], v[208:223]
    s_sub_u32 s54, s54, 1
    s_cmp_lg_u32 s54, 0
    v_exp_f32 v156, v156
    v_exp_f32 v157, v157
    v_exp_f32 v158, v158
    v_exp_f32 v159, v159
    v_cvt_pk_bf16_f32 v152, v152, v153
    v_cvt_pk_bf16_f32 v153, v154, v155
    v_cvt_pk_bf16_f32 v154, v156, v157
    v_cvt_pk_bf16_f32 v155, v158, v159
    s_cbranch_scc1 L_attn
    s_nop 0
    v_mfma_f32_32x32x16_bf16 v[208:223], v[92:95], v[152:155], v[208:223]
    s_setprio 2
    s_mov_b32 s48, 0x1f800000
    s_mov_b32 s54, 0x5f800000
    s_mov_b32 s55, 0x7b800000
    s_cmp_eq_u32 s78, 0
    s_cbranch_scc1 L_red0
L_red1:
    ds_write_b128 v226, v[160:163] offset:0
    ds_write_b128 v226, v[164:167] offset:1024
    ds_write_b96 v226, v[168:170] offset:2048
    ds_write_b128 v226, v[176:179] offset:3072
    ds_write_b128 v226, v[180:183] offset:4096
    ds_write_b96 v226, v[184:186] offset:5120
    s_waitcnt vmcnt(0) lgkmcnt(0)
    s_barrier
    ds_read_b96 v[168:170], v227 offset:2048
    ds_read_b96 v[184:186], v227 offset:5120
    ds_read_b128 v[160:163], v227 offset:0
    ds_read_b128 v[176:179], v227 offset:3072
    ds_read_b128 v[164:167], v227 offset:1024
    ds_read_b128 v[180:183], v227 offset:4096
    s_mov_b64 exec, 1
    buffer_store_dword v225, v224, s[40:43], 0 offen sc1
    s_mov_b64 exec, -1
    s_waitcnt lgkmcnt(4)
    v_add_f32 v202, v202, v170
    v_add_f32 v218, v218, v186
    v_add_f32 v200, v168, v200
    v_add_f32 v201, v169, v201
    v_add_f32 v216, v184, v216
    v_add_f32 v217, v185, v217
    v_min_f32 v2, v202, v218
    v_add_f32 v3, v202, v218
    v_cmp_nle_f32 s[58:59], s48, v2
    v_cmp_nge_f32 vcc, s54, v3
    v_maximum3_f32 v2, abs(v200), abs(v201), abs(v216)
    s_waitcnt lgkmcnt(2)
    v_add_f32 v192, v160, v192
    v_add_f32 v193, v161, v193
    v_add_f32 v208, v176, v208
    v_add_f32 v209, v177, v209
    v_add_f32 v194, v162, v194
    v_add_f32 v195, v163, v195
    v_add_f32 v210, v178, v210
    v_add_f32 v211, v179, v211
    s_or_b64 s[58:59], s[58:59], vcc
    v_maximum3_f32 v3, abs(v217), abs(v192), abs(v193)
    v_maximum3_f32 v2, v2, abs(v208), abs(v209)
    v_maximum3_f32 v3, v3, abs(v194), abs(v195)
    v_maximum3_f32 v2, v2, abs(v210), abs(v211)
    s_waitcnt lgkmcnt(0)
    v_add_f32 v196, v164, v196
    v_add_f32 v197, v165, v197
    v_add_f32 v212, v180, v212
    v_add_f32 v213, v181, v213
    v_add_f32 v198, v166, v198
    v_add_f32 v199, v167, v199
    v_add_f32 v214, v182, v214
    v_add_f32 v215, v183, v215
    v_maximum3_f32 v3, v3, abs(v196), abs(v197)
    v_maximum3_f32 v2, v2, abs(v212), abs(v213)
    v_maximum3_f32 v3, v3, abs(v198), abs(v199)
    v_maximum3_f32 v2, v2, abs(v214), abs(v215)
    v_maximum3_f32 v2, v2, v3, v3
    v_cmp_ngt_f32 vcc, s55, v2
    s_or_b64 s[58:59], s[58:59], vcc
    s_cbranch_scc1 L_fallback
    v_rcp_f32 v202, v202
    v_rcp_f32 v218, v218
    s_nop 0
    v_mul_f32 v192, v202, v192
    v_mul_f32 v193, v202, v193
    v_mul_f32 v194, v202, v194
    v_mul_f32 v195, v202, v195
    v_mul_f32 v196, v202, v196
    v_mul_f32 v197, v202, v197
    v_mul_f32 v198, v202, v198
    v_mul_f32 v199, v202, v199
    v_mul_f32 v200, v202, v200
    v_mul_f32 v201, v202, v201
    v_cvt_pk_bf16_f32 v160, v192, v193
    v_cvt_pk_bf16_f32 v161, v194, v195
    v_cvt_pk_bf16_f32 v162, v196, v197
    v_cvt_pk_bf16_f32 v163, v198, v199
    v_min_u32 v160, -2, v160
    v_min_u32 v161, -2, v161
    v_min_u32 v162, -2, v162
    v_min_u32 v163, -2, v163
    buffer_store_dwordx4 v[160:163], v244, s[40:43], s60 offen sc1
    v_cvt_pk_bf16_f32 v164, v200, v201
    v_min_u32 v164, -2, v164
    v_mul_f32 v208, v218, v208
    v_mul_f32 v209, v218, v209
    v_mul_f32 v210, v218, v210
    v_mul_f32 v211, v218, v211
    v_mul_f32 v212, v218, v212
    v_mul_f32 v213, v218, v213
    v_mul_f32 v214, v218, v214
    v_mul_f32 v215, v218, v215
    v_mul_f32 v216, v218, v216
    v_mul_f32 v217, v218, v217
    v_cvt_pk_bf16_f32 v176, v208, v209
    v_cvt_pk_bf16_f32 v177, v210, v211
    v_cvt_pk_bf16_f32 v178, v212, v213
    v_cvt_pk_bf16_f32 v179, v214, v215
    v_min_u32 v176, -2, v176
    v_min_u32 v177, -2, v177
    v_min_u32 v178, -2, v178
    v_min_u32 v179, -2, v179
    buffer_store_dwordx4 v[176:179], v244, s[40:43], s61 offen sc1
    v_cvt_pk_bf16_f32 v180, v216, v217
    v_min_u32 v180, -2, v180
    s_mov_b32 exec_hi, 0
    buffer_store_dword v164, v245, s[40:43], s62 offen sc1
    buffer_store_dword v180, v245, s[40:43], s63 offen sc1
    s_mov_b32 exec_hi, -1
    s_branch L_pub
L_red0:
    s_nop 5
    ds_write_b128 v226, v[192:195] offset:0
    ds_write_b128 v226, v[196:199] offset:1024
    ds_write_b96 v226, v[200:202] offset:2048
    ds_write_b128 v226, v[208:211] offset:3072
    ds_write_b128 v226, v[212:215] offset:4096
    ds_write_b96 v226, v[216:218] offset:5120
    s_waitcnt vmcnt(0) lgkmcnt(0)
    s_barrier
    ds_read_b96 v[200:202], v227 offset:2048
    ds_read_b96 v[216:218], v227 offset:5120
    ds_read_b128 v[192:195], v227 offset:0
    ds_read_b128 v[208:211], v227 offset:3072
    ds_read_b128 v[196:199], v227 offset:1024
    ds_read_b128 v[212:215], v227 offset:4096
    s_mov_b64 exec, 1
    buffer_store_dword v225, v224, s[40:43], 0 offen sc1
    s_mov_b64 exec, -1
    s_waitcnt lgkmcnt(4)
    v_add_f32 v170, v170, v202
    v_add_f32 v186, v186, v218
    v_add_f32 v168, v200, v168
    v_add_f32 v169, v201, v169
    v_add_f32 v184, v216, v184
    v_add_f32 v185, v217, v185
    v_min_f32 v2, v170, v186
    v_add_f32 v3, v170, v186
    v_cmp_nle_f32 s[58:59], s48, v2
    v_cmp_nge_f32 vcc, s54, v3
    v_maximum3_f32 v2, abs(v168), abs(v169), abs(v184)
    s_waitcnt lgkmcnt(2)
    v_add_f32 v160, v192, v160
    v_add_f32 v161, v193, v161
    v_add_f32 v176, v208, v176
    v_add_f32 v177, v209, v177
    v_add_f32 v162, v194, v162
    v_add_f32 v163, v195, v163
    v_add_f32 v178, v210, v178
    v_add_f32 v179, v211, v179
    s_or_b64 s[58:59], s[58:59], vcc
    v_maximum3_f32 v3, abs(v185), abs(v160), abs(v161)
    v_maximum3_f32 v2, v2, abs(v176), abs(v177)
    v_maximum3_f32 v3, v3, abs(v162), abs(v163)
    v_maximum3_f32 v2, v2, abs(v178), abs(v179)
    s_waitcnt lgkmcnt(0)
    v_add_f32 v164, v196, v164
    v_add_f32 v165, v197, v165
    v_add_f32 v180, v212, v180
    v_add_f32 v181, v213, v181
    v_add_f32 v166, v198, v166
    v_add_f32 v167, v199, v167
    v_add_f32 v182, v214, v182
    v_add_f32 v183, v215, v183
    v_maximum3_f32 v3, v3, abs(v164), abs(v165)
    v_maximum3_f32 v2, v2, abs(v180), abs(v181)
    v_maximum3_f32 v3, v3, abs(v166), abs(v167)
    v_maximum3_f32 v2, v2, abs(v182), abs(v183)
    v_maximum3_f32 v2, v2, v3, v3
    v_cmp_ngt_f32 vcc, s55, v2
    s_or_b64 s[58:59], s[58:59], vcc
    s_cbranch_scc1 L_fallback
L_norm:
    v_rcp_f32 v170, v170
    v_rcp_f32 v186, v186
    s_nop 0
    v_mul_f32 v160, v170, v160
    v_mul_f32 v161, v170, v161
    v_mul_f32 v162, v170, v162
    v_mul_f32 v163, v170, v163
    v_mul_f32 v164, v170, v164
    v_mul_f32 v165, v170, v165
    v_mul_f32 v166, v170, v166
    v_mul_f32 v167, v170, v167
    v_mul_f32 v168, v170, v168
    v_mul_f32 v169, v170, v169
    v_cvt_pk_bf16_f32 v192, v160, v161
    v_cvt_pk_bf16_f32 v193, v162, v163
    v_cvt_pk_bf16_f32 v194, v164, v165
    v_cvt_pk_bf16_f32 v195, v166, v167
    v_min_u32 v192, -2, v192
    v_min_u32 v193, -2, v193
    v_min_u32 v194, -2, v194
    v_min_u32 v195, -2, v195
    buffer_store_dwordx4 v[192:195], v244, s[40:43], s60 offen sc1
    v_cvt_pk_bf16_f32 v196, v168, v169
    v_min_u32 v196, -2, v196
    v_mul_f32 v176, v186, v176
    v_mul_f32 v177, v186, v177
    v_mul_f32 v178, v186, v178
    v_mul_f32 v179, v186, v179
    v_mul_f32 v180, v186, v180
    v_mul_f32 v181, v186, v181
    v_mul_f32 v182, v186, v182
    v_mul_f32 v183, v186, v183
    v_mul_f32 v184, v186, v184
    v_mul_f32 v185, v186, v185
    v_cvt_pk_bf16_f32 v208, v176, v177
    v_cvt_pk_bf16_f32 v209, v178, v179
    v_cvt_pk_bf16_f32 v210, v180, v181
    v_cvt_pk_bf16_f32 v211, v182, v183
    v_min_u32 v208, -2, v208
    v_min_u32 v209, -2, v209
    v_min_u32 v210, -2, v210
    v_min_u32 v211, -2, v211
    buffer_store_dwordx4 v[208:211], v244, s[40:43], s61 offen sc1
    v_cvt_pk_bf16_f32 v212, v184, v185
    v_min_u32 v212, -2, v212
    s_mov_b32 exec_hi, 0
    buffer_store_dword v196, v245, s[40:43], s62 offen sc1
    buffer_store_dword v212, v245, s[40:43], s63 offen sc1
    s_mov_b32 exec_hi, -1
L_pub:
    buffer_load_dword v250, v254, s[40:43], 0 offen sc1
    s_mov_b32 s56, 0
    s_mov_b32 s57, 0
    s_mov_b32 s63, 0
    ds_read_b64_tr_b16 v[16:17], v236 offset:0
    ds_read_b64_tr_b16 v[18:19], v236 offset:1024
    ds_read_b64_tr_b16 v[20:21], v237 offset:0
    ds_read_b64_tr_b16 v[22:23], v237 offset:1024
    ds_read_b64_tr_b16 v[24:25], v236 offset:2560
    ds_read_b64_tr_b16 v[26:27], v236 offset:3584
    ds_read_b64_tr_b16 v[28:29], v237 offset:2560
    ds_read_b64_tr_b16 v[30:31], v237 offset:3584
    ds_read_b64_tr_b16 v[32:33], v236 offset:4608
    ds_read_b64_tr_b16 v[34:35], v236 offset:5632
    ds_read_b64_tr_b16 v[36:37], v237 offset:4608
    ds_read_b64_tr_b16 v[38:39], v237 offset:5632
    ds_read_b64_tr_b16 v[40:41], v236 offset:7168
    ds_read_b64_tr_b16 v[42:43], v236 offset:8192
    ds_read_b64_tr_b16 v[44:45], v237 offset:7168
    ds_read_b64_tr_b16 v[46:47], v237 offset:8192
    ds_read_b64_tr_b16 v[48:49], v236 offset:9216
    ds_read_b64_tr_b16 v[50:51], v236 offset:10240
    ds_read_b64_tr_b16 v[52:53], v237 offset:9216
    ds_read_b64_tr_b16 v[54:55], v237 offset:10240
    ds_read_b64_tr_b16 v[56:57], v236 offset:11776
    ds_read_b64_tr_b16 v[58:59], v236 offset:12800
    ds_read_b64_tr_b16 v[60:61], v237 offset:11776
    ds_read_b64_tr_b16 v[62:63], v237 offset:12800
    ds_read_b64_tr_b16 v[64:65], v236 offset:13824
    ds_read_b64_tr_b16 v[66:67], v236 offset:14848
    ds_read_b64_tr_b16 v[68:69], v237 offset:13824
    ds_read_b64_tr_b16 v[70:71], v237 offset:14848
    ds_read_b64_tr_b16 v[72:73], v236 offset:16384
    ds_read_b64_tr_b16 v[74:75], v236 offset:17408
    ds_read_b64_tr_b16 v[76:77], v237 offset:16384
    ds_read_b64_tr_b16 v[78:79], v237 offset:17408
    ds_read_b64_tr_b16 v[80:81], v238 offset:0
    ds_read_b64_tr_b16 v[82:83], v238 offset:4608
    ds_read_b64_tr_b16 v[84:85], v239 offset:0
    ds_read_b64_tr_b16 v[86:87], v239 offset:4608
    s_cmp_eq_u32 s69, 0
    s_cbranch_scc1 L_ne19
    ds_read_b64_tr_b16 v[88:89], v240 offset:0
    ds_read_b64_tr_b16 v[90:91], v240 offset:512
    ds_read_b64_tr_b16 v[92:93], v240 offset:1280
    ds_read_b64_tr_b16 v[94:95], v240 offset:1792
    ds_read_b64_tr_b16 v[96:97], v240 offset:2304
    ds_read_b64_tr_b16 v[98:99], v240 offset:2816
    ds_read_b64_tr_b16 v[100:101], v240 offset:3584
    ds_read_b64_tr_b16 v[102:103], v240 offset:4096
    ds_read_b64_tr_b16 v[104:105], v240 offset:4608
    ds_read_b64_tr_b16 v[106:107], v240 offset:5120
    ds_read_b64_tr_b16 v[108:109], v240 offset:5888
    ds_read_b64_tr_b16 v[110:111], v240 offset:6400
    ds_read_b64_tr_b16 v[112:113], v240 offset:6912
    ds_read_b64_tr_b16 v[114:115], v240 offset:7424
    ds_read_b64_tr_b16 v[116:117], v240 offset:8192
    ds_read_b64_tr_b16 v[118:119], v240 offset:8704
    ds_read_b64_tr_b16 v[120:121], v241 offset:0
    ds_read_b64_tr_b16 v[122:123], v241 offset:2304
L_ne19:
    s_waitcnt lgkmcnt(0)
    s_mov_b64 exec, 1
    ds_add_u32 v246, v247 offset:52
    s_mov_b64 exec, -1
    s_setprio 0
    s_branch L_final
L_fallback:
    v_mov_b32 v8, v252
    v_mov_b32 v9, v253
    v_and_b32 v1, 31, v0
    v_lshrrev_b32 v2, 5, v0
    v_lshlrev_b32 v3, 4, v1
    v_lshl_add_u32 v3, v2, 8, v3
    v_add_u32 v3, 1024, v3
    v_subrev_u32 v4, 16, v1
    v_lshlrev_b32 v5, 4, v4
    v_lshl_add_u32 v5, v2, 5, v5
    v_add_u32 v5, 2048, v5
    v_cmp_gt_u32 vcc, 2, v4
    v_add_u32 v6, 64, v5
    v_mov_b32 v7, 0x40000000
    v_cndmask_b32 v5, v7, v5, vcc
    v_cndmask_b32 v6, v7, v6, vcc
    v_and_b32 v4, 27, v1
    v_cmp_eq_u32 vcc, 18, v4
    v_mov_b32 v7, 2176
    s_nop 0
    v_cndmask_b32 v5, v5, v7, vcc
    v_cndmask_b32 v6, v6, v7, vcc
    v_cmp_gt_u32 vcc, 16, v1
    v_add_u32 v4, 512, v3
    s_nop 0
    v_cndmask_b32 v252, v5, v3, vcc
    v_cndmask_b32 v253, v6, v4, vcc
    v_mov_b32 v10, v252
    v_mov_b32 v11, v253
    v_mov_b32 v252, v8
    v_mov_b32 v253, v9
    s_bitcmp1_b32 s47, 0
    s_mov_b32 s52, 166144
    s_cselect_b32 s52, 2308, s52
    v_and_b32 v3, 31, v0
    v_lshl_add_u32 v3, v3, 3, s52
    s_mul_i32 s50, s47, 163840
    s_add_u32 s50, s50, 0x240000
    s_add_u32 s51, s50, 163840
    s_cmp_eq_u32 s78, 0
    s_cbranch_scc1 L_fb0
    v_mov_b32 v16, v24
    v_mov_b32 v17, v25
    v_mov_b32 v18, v26
    v_mov_b32 v19, v27
    v_mov_b32 v20, v28
    v_mov_b32 v21, v29
    v_mov_b32 v22, v30
    v_mov_b32 v23, v31
    v_mov_b32 v32, v34
L_fb0:
    v_mov_b32 v36, 0xff800000
    v_mov_b32 v37, 0xff800000
    v_mov_b32 v160, 0
    v_mov_b32 v161, 0
    v_mov_b32 v162, 0
    v_mov_b32 v163, 0
    v_mov_b32 v164, 0
    v_mov_b32 v165, 0
    v_mov_b32 v166, 0
    v_mov_b32 v167, 0
    v_mov_b32 v168, 0
    v_mov_b32 v169, 0
    v_mov_b32 v170, 0
    v_mov_b32 v171, 0
    v_mov_b32 v172, 0
    v_mov_b32 v173, 0
    v_mov_b32 v174, 0
    v_mov_b32 v175, 0
    v_mov_b32 v176, 0
    v_mov_b32 v177, 0
    v_mov_b32 v178, 0
    v_mov_b32 v179, 0
    v_mov_b32 v180, 0
    v_mov_b32 v181, 0
    v_mov_b32 v182, 0
    v_mov_b32 v183, 0
    v_mov_b32 v184, 0
    v_mov_b32 v185, 0
    v_mov_b32 v186, 0
    v_mov_b32 v187, 0
    v_mov_b32 v188, 0
    v_mov_b32 v189, 0
    v_mov_b32 v190, 0
    v_mov_b32 v191, 0
    s_mov_b32 s52, s50
L_fbloop0:
    buffer_load_dwordx4 v[40:43], v244, s[40:43], s52 offen sc1
    buffer_load_dword v56, v3, s[40:43], s52 offen sc1
    s_waitcnt vmcnt(0)
    v_mfma_f32_32x32x4_2b_bf16 v[96:127], v[56:57], v[32:33], 0 cbsz:1 abid:0
    s_nop 15
    s_nop 1
    v_mfma_f32_32x32x16_bf16 v[96:111], v[40:43], v[16:19], v[96:111]
    v_mfma_f32_32x32x16_bf16 v[112:127], v[40:43], v[20:23], v[112:127]
    s_nop 11
    v_max3_f32 v36, v96, v97, v36
    v_max3_f32 v36, v98, v99, v36
    v_max3_f32 v36, v100, v101, v36
    v_max3_f32 v36, v102, v103, v36
    v_max3_f32 v36, v104, v105, v36
    v_max3_f32 v36, v106, v107, v36
    v_max3_f32 v36, v108, v109, v36
    v_max3_f32 v36, v110, v111, v36
    v_max3_f32 v37, v112, v113, v37
    v_max3_f32 v37, v114, v115, v37
    v_max3_f32 v37, v116, v117, v37
    v_max3_f32 v37, v118, v119, v37
    v_max3_f32 v37, v120, v121, v37
    v_max3_f32 v37, v122, v123, v37
    v_max3_f32 v37, v124, v125, v37
    v_max3_f32 v37, v126, v127, v37
    s_add_u32 s52, s52, 2560
    s_cmp_lg_u32 s52, s51
    s_cbranch_scc1 L_fbloop0
    v_mov_b32 v96, v36
    v_mov_b32 v97, v37
    s_nop 1
    v_permlane32_swap_b32 v96, v36
    v_permlane32_swap_b32 v97, v37
    s_nop 0
    v_max_f32 v36, v36, v96
    v_max_f32 v37, v37, v97
    s_mov_b32 s52, s50
L_fbloop1:
    buffer_load_dwordx4 v[40:43], v244, s[40:43], s52 offen sc1
    buffer_load_dword v56, v3, s[40:43], s52 offen sc1
    buffer_load_dwordx4 v[64:67], v10, s[40:43], s52 offen sc1
    buffer_load_dwordx4 v[68:71], v11, s[40:43], s52 offen sc1
    s_waitcnt vmcnt(0)
    v_mfma_f32_32x32x4_2b_bf16 v[96:127], v[56:57], v[32:33], 0 cbsz:1 abid:0
    s_nop 15
    s_nop 1
    v_mfma_f32_32x32x16_bf16 v[96:111], v[40:43], v[16:19], v[96:111]
    v_mfma_f32_32x32x16_bf16 v[112:127], v[40:43], v[20:23], v[112:127]
    s_nop 11
    v_sub_f32 v96, v96, v36
    v_sub_f32 v97, v97, v36
    v_sub_f32 v98, v98, v36
    v_sub_f32 v99, v99, v36
    v_sub_f32 v100, v100, v36
    v_sub_f32 v101, v101, v36
    v_sub_f32 v102, v102, v36
    v_sub_f32 v103, v103, v36
    v_sub_f32 v104, v104, v36
    v_sub_f32 v105, v105, v36
    v_sub_f32 v106, v106, v36
    v_sub_f32 v107, v107, v36
    v_sub_f32 v108, v108, v36
    v_sub_f32 v109, v109, v36
    v_sub_f32 v110, v110, v36
    v_sub_f32 v111, v111, v36
    v_sub_f32 v112, v112, v37
    v_sub_f32 v113, v113, v37
    v_sub_f32 v114, v114, v37
    v_sub_f32 v115, v115, v37
    v_sub_f32 v116, v116, v37
    v_sub_f32 v117, v117, v37
    v_sub_f32 v118, v118, v37
    v_sub_f32 v119, v119, v37
    v_sub_f32 v120, v120, v37
    v_sub_f32 v121, v121, v37
    v_sub_f32 v122, v122, v37
    v_sub_f32 v123, v123, v37
    v_sub_f32 v124, v124, v37
    v_sub_f32 v125, v125, v37
    v_sub_f32 v126, v126, v37
    v_sub_f32 v127, v127, v37
    v_exp_f32 v96, v96
    v_exp_f32 v97, v97
    v_exp_f32 v98, v98
    v_exp_f32 v99, v99
    v_exp_f32 v100, v100
    v_exp_f32 v101, v101
    v_exp_f32 v102, v102
    v_exp_f32 v103, v103
    v_exp_f32 v104, v104
    v_exp_f32 v105, v105
    v_exp_f32 v106, v106
    v_exp_f32 v107, v107
    v_exp_f32 v108, v108
    v_exp_f32 v109, v109
    v_exp_f32 v110, v110
    v_exp_f32 v111, v111
    v_exp_f32 v112, v112
    v_exp_f32 v113, v113
    v_exp_f32 v114, v114
    v_exp_f32 v115, v115
    v_exp_f32 v116, v116
    v_exp_f32 v117, v117
    v_exp_f32 v118, v118
    v_exp_f32 v119, v119
    v_exp_f32 v120, v120
    v_exp_f32 v121, v121
    v_exp_f32 v122, v122
    v_exp_f32 v123, v123
    v_exp_f32 v124, v124
    v_exp_f32 v125, v125
    v_exp_f32 v126, v126
    v_exp_f32 v127, v127
    v_cvt_pk_bf16_f32 v96, v96, v97
    v_cvt_pk_bf16_f32 v97, v98, v99
    v_cvt_pk_bf16_f32 v98, v100, v101
    v_cvt_pk_bf16_f32 v99, v102, v103
    v_cvt_pk_bf16_f32 v104, v104, v105
    v_cvt_pk_bf16_f32 v105, v106, v107
    v_cvt_pk_bf16_f32 v106, v108, v109
    v_cvt_pk_bf16_f32 v107, v110, v111
    v_cvt_pk_bf16_f32 v112, v112, v113
    v_cvt_pk_bf16_f32 v113, v114, v115
    v_cvt_pk_bf16_f32 v114, v116, v117
    v_cvt_pk_bf16_f32 v115, v118, v119
    v_cvt_pk_bf16_f32 v120, v120, v121
    v_cvt_pk_bf16_f32 v121, v122, v123
    v_cvt_pk_bf16_f32 v122, v124, v125
    v_cvt_pk_bf16_f32 v123, v126, v127
    s_nop 0
    v_mfma_f32_32x32x16_bf16 v[160:175], v[64:67], v[96:99], v[160:175]
    v_mfma_f32_32x32x16_bf16 v[160:175], v[68:71], v[104:107], v[160:175]
    v_mfma_f32_32x32x16_bf16 v[176:191], v[64:67], v[112:115], v[176:191]
    v_mfma_f32_32x32x16_bf16 v[176:191], v[68:71], v[120:123], v[176:191]
    s_add_u32 s52, s52, 2560
    s_cmp_lg_u32 s52, s51
    s_cbranch_scc1 L_fbloop1
    s_nop 11
    s_branch L_norm
L_pidle0:
    s_sub_u32 s48, s74, 28
    s_lshl_b32 s48, s48, 3
    s_add_u32 s48, s48, s44
    v_mul_u32_u24 v1, 1152, v0
    v_mul_u32_u24 v2, 3456, v0
    s_lshr_b32 s52, s75, 1
    s_mul_i32 s52, s52, 589824
    s_and_b32 s53, s75, 1
    s_mul_i32 s53, s53, 1792
L_pf20:
    s_mul_i32 s49, s48, 2979
    s_lshr_b32 s49, s49, 16
    s_mul_i32 s50, s49, 22
    s_sub_u32 s50, s48, s50
    s_cmp_ge_u32 s50, 8
    s_cbranch_scc1 L_pfw21
    s_mul_i32 s50, s50, 73728
    s_lshl_b32 s49, s49, 7
    s_add_u32 s50, s50, s49
    s_add_u32 s50, s50, s52
    buffer_load_dword v3, v1, s[12:15], s50 offen
    s_branch L_pfn22
L_pfw21:
    s_sub_u32 s50, s50, 8
    s_lshl_b32 s50, s50, 7
    s_mul_i32 s49, s49, 221184
    s_add_u32 s50, s50, s49
    s_add_u32 s50, s50, s53
    buffer_load_dword v3, v2, s[16:19], s50 offen
L_pfn22:
    s_add_u32 s48, s48, 32
    s_cmp_lt_u32 s48, 198
    s_cbranch_scc1 L_pf20
    s_waitcnt vmcnt(0) lgkmcnt(0)
    s_barrier
    s_barrier
    ds_read_b32 v250, v246 offset:40
    s_branch L_ppath
L_lset:
    s_load_dwordx2 s[20:21], s[0:1], 16
    s_load_dwordx2 s[24:25], s[0:1], 24
    s_load_dwordx2 s[28:29], s[0:1], 48
    s_load_dwordx2 s[32:33], s[0:1], 56
    s_mov_b32 s14, 0x240000
    s_mov_b32 s15, 0x20000
    s_mov_b32 s18, 0x1e6000
    s_mov_b32 s19, 0x20000
    s_mov_b32 s22, 0x5100
    s_mov_b32 s23, 0x20000
    s_mov_b32 s26, 0xa2000
    s_mov_b32 s27, 0x20000
    s_mov_b32 s30, 0xa2000
    s_mov_b32 s31, 0x20000
    s_mov_b32 s34, 0x480000
    s_mov_b32 s35, 0x20000
    s_mov_b32 s38, 0x100
    s_mov_b32 s39, 0x20000
    s_mov_b32 s42, 0x1800000
    s_mov_b32 s43, 0x20000
    s_mov_b32 s64, 0xdd9a4
    s_cmp_eq_u32 s45, 1
    s_cselect_b32 s64, 0xedea28, s64
    s_cmp_eq_u32 s45, 2
    s_cselect_b32 s64, 0x1dab060, s64
    s_cmp_eq_u32 s45, 3
    s_cselect_b32 s64, 0x2bcc0e0, s64
    s_cmp_eq_u32 s45, 4
    s_cselect_b32 s64, 0x39dd162, s64
    s_cmp_eq_u32 s45, 5
    s_cselect_b32 s64, 0x47de1e6, s64
    s_cmp_eq_u32 s45, 6
    s_cselect_b32 s64, 0x569a820, s64
    s_cmp_eq_u32 s45, 7
    s_cselect_b32 s64, 0x64bb8a0, s64
    s_cmp_eq_u32 s45, 8
    s_cselect_b32 s64, 0x72dc920, s64
    s_lshr_b32 s65, s64, 20
    v_mov_b32 v39, s64
    s_lshl_b32 s79, s46, 2
    s_lshl_b32 s3, s77, 1
    s_add_u32 s79, s79, s3
    s_cmp_le_u32 s45, 4
    s_cselect_b32 s66, 1, 0
    s_cmp_eq_u32 s97, 0
    s_cselect_b32 s66, s66, 0
    s_cmp_ge_u32 s74, 28
    s_cselect_b32 s67, 1, 0
    v_lshlrev_b32 v244, 4, v0
    v_lshlrev_b32 v245, 2, v0
    s_waitcnt lgkmcnt(0)
    s_cmp_lg_u32 s67, 0
    s_cbranch_scc1 L_lidle
    v_and_b32 v1, 31, v0
    v_lshrrev_b32 v2, 5, v0
    v_cmp_eq_u32 vcc, 20, v1
    v_mov_b32 v3, 17
    v_mov_b32 v4, 0x40000000
    v_cndmask_b32 v3, v1, v3, vcc
    v_cmp_ge_u32 s[48:49], 16, v1
    s_or_b64 vcc, vcc, s[48:49]
    v_lshlrev_b32 v3, 1, v3
    s_mul_i32 s50, s47, 648
    v_cndmask_b32 v3, v4, v3, vcc
    v_mul_u32_u24 v5, 288, v2
    v_add_u32 v4, v3, v5
    s_and_b32 s48, s47, 1
    s_mul_i32 s49, s48, 72
    s_add_u32 s51, s50, s49
    s_mul_i32 s49, s48, 576
    s_sub_u32 s50, s50, s49
    s_add_u32 s50, s50, 576
    buffer_load_ushort v160, v4, s[20:23], s51 offen offset:0
    buffer_load_ushort v161, v4, s[20:23], s51 offen offset:36
    buffer_load_ushort v162, v4, s[20:23], s51 offen offset:72
    buffer_load_ushort v163, v4, s[20:23], s51 offen offset:108
    buffer_load_ushort v164, v4, s[20:23], s51 offen offset:144
    buffer_load_ushort v165, v4, s[20:23], s51 offen offset:180
    buffer_load_ushort v166, v4, s[20:23], s51 offen offset:216
    buffer_load_ushort v167, v4, s[20:23], s51 offen offset:252
    buffer_load_ushort v168, v3, s[20:23], s50 offen
    buffer_load_ushort v169, v3, s[20:23], s50 offen offset:36
    s_waitcnt vmcnt(18)
    s_barrier
    s_lshl_b32 s3, s96, 12
    s_add_u32 m0, s3, 65536
    s_add_u32 vcc_lo, s98, 256
    s_add_u32 vcc_hi, s99, 442368
    buffer_load_dwordx4 v228, s[4:7], vcc_lo offen offset:0 lds
    buffer_load_dwordx4 v229, s[4:7], vcc_lo offen offset:1024 lds
    buffer_load_dwordx4 v230, s[4:7], vcc_lo offen offset:2048 lds
    buffer_load_dwordx4 v231, s[4:7], vcc_lo offen offset:3072 lds
    s_add_u32 m0, s3, 81920
    s_nop 0
    buffer_load_dwordx4 v232, s[8:11], vcc_hi offen offset:0 lds
    buffer_load_dwordx4 v233, s[8:11], vcc_hi offen offset:1024 lds
    buffer_load_dwordx4 v234, s[8:11], vcc_hi offen offset:2048 lds
    buffer_load_dwordx4 v235, s[8:11], vcc_hi offen offset:3072 lds
    v_and_b32 v1, 31, v0
    v_lshrrev_b32 v2, 5, v0
    v_lshlrev_b32 v3, 4, v1
    v_lshl_add_u32 v3, v2, 8, v3
    v_add_u32 v3, 1024, v3
    v_subrev_u32 v4, 16, v1
    v_lshlrev_b32 v5, 4, v4
    v_lshl_add_u32 v5, v2, 5, v5
    v_add_u32 v5, 2048, v5
    v_cmp_gt_u32 vcc, 2, v4
    v_add_u32 v6, 64, v5
    v_mov_b32 v7, 0x40000000
    v_cndmask_b32 v5, v7, v5, vcc
    v_cndmask_b32 v6, v7, v6, vcc
    v_and_b32 v4, 27, v1
    v_cmp_eq_u32 vcc, 18, v4
    v_mov_b32 v7, 2176
    s_nop 0
    v_cndmask_b32 v5, v5, v7, vcc
    v_cndmask_b32 v6, v6, v7, vcc
    v_cmp_gt_u32 vcc, 16, v1
    v_add_u32 v4, 512, v3
    s_nop 0
    v_cndmask_b32 v21, v5, v3, vcc
    v_cndmask_b32 v22, v6, v4, vcc
    s_lshl_b32 s58, s68, 3
    s_lshl_b32 s49, s96, 1
    s_add_u32 s58, s58, s49
    s_lshl_b32 s49, s47, 6
    s_add_u32 s48, s58, s49
    s_lshl_b32 s56, s48, 10
    s_add_u32 s56, s56, 0x740000
    s_mul_i32 s57, s48, 2560
    s_add_u32 s57, s57, 0x980000
    s_lshr_b32 s48, s47, 1
    s_lshl_b32 s48, s48, 6
    s_add_u32 s48, s48, s58
    s_lshl_b32 s48, s48, 8
    s_and_b32 s49, s47, 1
    s_lshl_b32 s49, s49, 2
    s_add_u32 s48, s48, s49
    s_add_u32 s48, s48, 0x940000
    v_mov_b32 v3, s48
    s_bitcmp1_b32 s47, 0
    s_mov_b32 s49, 166144
    s_cselect_b32 s49, 2308, s49
    s_add_u32 s49, s49, s57
    v_mov_b32 v4, s49
    v_mov_b32 v5, 256
    v_mov_b32 v6, 2560
    v_cmp_gt_u32 vcc, 32, v0
    v_and_b32 v1, 31, v0
    v_lshrrev_b32 v2, 5, v0
    v_cndmask_b32 v3, v4, v3, vcc
    v_cndmask_b32 v5, v6, v5, vcc
    v_lshl_add_u32 v16, v1, 3, v3
    v_add_u32 v17, v16, v5
    s_lshl_b32 s59, s45, 4
    s_add_u32 s59, s59, s46
    s_lshl_b32 s59, s59, 7
    s_add_u32 s59, s59, 0x1428000
    s_cmp_lg_u32 s67, 0
    s_cselect_b32 s59, 0x40000000, s59
    s_waitcnt vmcnt(18)
    s_barrier
    s_lshl_b32 s3, s96, 12
    s_add_u32 m0, s3, 98304
    s_add_u32 vcc_lo, s98, 384
    s_add_u32 vcc_hi, s99, 663552
    buffer_load_dwordx4 v228, s[4:7], vcc_lo offen offset:0 lds
    buffer_load_dwordx4 v229, s[4:7], vcc_lo offen offset:1024 lds
    buffer_load_dwordx4 v230, s[4:7], vcc_lo offen offset:2048 lds
    buffer_load_dwordx4 v231, s[4:7], vcc_lo offen offset:3072 lds
    s_add_u32 m0, s3, 114688
    s_nop 0
    buffer_load_dwordx4 v232, s[8:11], vcc_hi offen offset:0 lds
    buffer_load_dwordx4 v233, s[8:11], vcc_hi offen offset:1024 lds
    buffer_load_dwordx4 v234, s[8:11], vcc_hi offen offset:2048 lds
    buffer_load_dwordx4 v235, s[8:11], vcc_hi offen offset:3072 lds
    s_mul_i32 s3, s96, 6656
    s_add_u32 s3, s3, 131072
    v_add_u32 v1, s3, v244
    ds_read_b128 v[24:27], v1 offset:0
    ds_read_b128 v[28:31], v1 offset:1024
    ds_read_b128 v[72:75], v1 offset:2048
    ds_read_b128 v[76:79], v1 offset:3072
    ds_read_b128 v[80:83], v1 offset:4096
    s_waitcnt vmcnt(8)
    s_barrier
    s_lshl_b32 s3, s96, 12
    s_add_u32 m0, s3, 0
    s_add_u32 vcc_lo, s98, 512
    s_add_u32 vcc_hi, s99, 884736
    buffer_load_dwordx4 v228, s[4:7], vcc_lo offen offset:0 lds
    buffer_load_dwordx4 v229, s[4:7], vcc_lo offen offset:1024 lds
    buffer_load_dwordx4 v230, s[4:7], vcc_lo offen offset:2048 lds
    buffer_load_dwordx4 v231, s[4:7], vcc_lo offen offset:3072 lds
    s_add_u32 m0, s3, 16384
    s_nop 0
    buffer_load_dwordx4 v232, s[8:11], vcc_hi offen offset:0 lds
    buffer_load_dwordx4 v233, s[8:11], vcc_hi offen offset:1024 lds
    buffer_load_dwordx4 v234, s[8:11], vcc_hi offen offset:2048 lds
    buffer_load_dwordx4 v235, s[8:11], vcc_hi offen offset:3072 lds
    s_waitcnt lgkmcnt(0)
    v_add_u32 v72, 0x740000, v72
    v_add_u32 v73, 0x740000, v73
    v_add_u32 v74, 0x740000, v74
    v_add_u32 v75, 0x740000, v75
    v_add_u32 v76, 0x740000, v76
    v_add_u32 v77, 0x740000, v77
    v_add_u32 v78, 0x740000, v78
    v_add_u32 v79, 0x740000, v79
    v_add_u32 v80, 0x740000, v80
    v_add_u32 v81, 0x740000, v81
    v_add_u32 v82, 0x740000, v82
    v_add_u32 v83, 0x740000, v83
    s_waitcnt vmcnt(8)
    s_barrier
    s_lshl_b32 s3, s96, 12
    s_add_u32 m0, s3, 32768
    s_add_u32 vcc_lo, s98, 640
    s_add_u32 vcc_hi, s99, 1105920
    buffer_load_dwordx4 v228, s[4:7], vcc_lo offen offset:0 lds
    buffer_load_dwordx4 v229, s[4:7], vcc_lo offen offset:1024 lds
    buffer_load_dwordx4 v230, s[4:7], vcc_lo offen offset:2048 lds
    buffer_load_dwordx4 v231, s[4:7], vcc_lo offen offset:3072 lds
    s_add_u32 m0, s3, 49152
    s_nop 0
    buffer_load_dwordx4 v232, s[8:11], vcc_hi offen offset:0 lds
    buffer_load_dwordx4 v233, s[8:11], vcc_hi offen offset:1024 lds
    buffer_load_dwordx4 v234, s[8:11], vcc_hi offen offset:2048 lds
    buffer_load_dwordx4 v235, s[8:11], vcc_hi offen offset:3072 lds
    s_lshr_b32 s74, s44, 2
    s_xor_b32 s74, s74, s77
    s_and_b32 s3, s72, 5
    s_cmp_eq_u32 s3, s77
    s_cselect_b32 s75, 1, 0
    s_or_b32 s69, s74, 4
    s_cmp_eq_u32 s3, s69
    s_cselect_b32 s69, 1, 0
    s_mul_i32 s50, s78, 18432
    s_add_u32 s50, s50, 102400
    s_mul_i32 s51, s78, 9216
    s_add_u32 s51, s51, 139264
    v_bfe_u32 v2, v0, 2, 2
    v_lshrrev_b32 v3, 5, v0
    v_and_b32 v4, 3, v0
    v_bfe_u32 v5, v0, 4, 1
    v_lshl_add_u32 v4, v5, 2, v4
    v_lshlrev_b32 v4, 3, v4
    v_lshl_add_u32 v2, v3, 2, v2
    v_lshl_add_u32 v240, v2, 6, v4
    v_add_u32 v240, s51, v240
    v_bfe_u32 v5, v0, 3, 1
    v_lshl_add_u32 v4, v5, 6, v4
    v_lshl_add_u32 v236, v2, 7, v4
    v_add_u32 v236, s50, v236
    v_xor_b32 v237, 64, v236
    v_mul_u32_u24 v3, 68, v3
    v_add_u32 v3, 16, v3
    v_lshl_add_u32 v238, v3, 7, v236
    v_lshl_add_u32 v239, v3, 7, v237
    v_lshl_add_u32 v241, v3, 6, v240
    s_lshl_b32 s48, s71, 1
    s_add_u32 s48, s48, s78
    s_lshl_b32 s48, s48, 11
    s_add_u32 s48, s48, 0x1440000
    v_and_b32 v3, 15, v0
    v_lshl_add_u32 v242, v3, 7, s48
    v_and_b32 v3, 7, v0
    s_lshl_b32 s48, s47, 10
    s_add_u32 s48, s48, 0x1430000
    v_lshl_add_u32 v243, v3, 7, s48
    s_mov_b32 s60, 0x1f800000
    s_mov_b32 s61, 0x5f800000
    s_waitcnt vmcnt(8)
    s_barrier
    s_lshl_b32 s3, s96, 12
    s_add_u32 m0, s3, 65536
    s_add_u32 vcc_lo, s98, 768
    s_add_u32 vcc_hi, s99, 1327104
    buffer_load_dwordx4 v228, s[4:7], vcc_lo offen offset:0 lds
    buffer_load_dwordx4 v229, s[4:7], vcc_lo offen offset:1024 lds
    buffer_load_dwordx4 v230, s[4:7], vcc_lo offen offset:2048 lds
    buffer_load_dwordx4 v231, s[4:7], vcc_lo offen offset:3072 lds
    s_add_u32 m0, s3, 81920
    s_nop 0
    buffer_load_dwordx4 v232, s[8:11], vcc_hi offen offset:0 lds
    buffer_load_dwordx4 v233, s[8:11], vcc_hi offen offset:1024 lds
    buffer_load_dwordx4 v234, s[8:11], vcc_hi offen offset:2048 lds
    buffer_load_dwordx4 v235, s[8:11], vcc_hi offen offset:3072 lds
    v_lshrrev_b32 v3, 3, v0
    v_bfe_u32 v4, v0, 4, 1
    v_lshlrev_b32 v4, 2, v4
    v_and_b32 v5, 7, v0
    v_xor_b32 v4, v4, v5
    v_mul_u32_u24 v3, 1152, v3
    v_lshl_add_u32 v224, v4, 4, v3
    v_lshrrev_b32 v3, 2, v0
    v_mul_u32_u24 v3, 1152, v3
    v_and_b32 v4, 3, v0
    v_lshl_add_u32 v225, v4, 4, v3
    v_lshrrev_b32 v4, 1, v0
    v_min_u32 v4, 2, v4
    v_and_b32 v5, 1, v0
    s_lshr_b32 s48, s47, 1
    s_mul_i32 s48, s48, 36
    s_and_b32 s49, s47, 1
    s_lshl_b32 s49, s49, 4
    s_add_u32 s48, s48, s49
    v_mul_u32_u24 v3, 576, v4
    v_mul_u32_u24 v6, 19, v5
    v_add3_u32 v3, v3, v6, s48
    v_lshrrev_b32 v3, 7, v3
    s_lshl_b32 s48, s68, 1
    s_add_u32 s48, s48, s78
    v_lshl_add_u32 v3, v3, 4, s48
    v_lshlrev_b32 v3, 7, v3
    v_add_u32 v249, 0x1428000, v3
    s_waitcnt vmcnt(8)
    s_barrier
    s_lshl_b32 s3, s96, 12
    s_add_u32 m0, s3, 98304
    s_add_u32 vcc_lo, s98, 896
    s_add_u32 vcc_hi, s99, 1548288
    buffer_load_dwordx4 v228, s[4:7], vcc_lo offen offset:0 lds
    buffer_load_dwordx4 v229, s[4:7], vcc_lo offen offset:1024 lds
    buffer_load_dwordx4 v230, s[4:7], vcc_lo offen offset:2048 lds
    buffer_load_dwordx4 v231, s[4:7], vcc_lo offen offset:3072 lds
    s_add_u32 m0, s3, 114688
    s_nop 0
    buffer_load_dwordx4 v232, s[8:11], vcc_hi offen offset:0 lds
    buffer_load_dwordx4 v233, s[8:11], vcc_hi offen offset:1024 lds
    buffer_load_dwordx4 v234, s[8:11], vcc_hi offen offset:2048 lds
    buffer_load_dwordx4 v235, s[8:11], vcc_hi offen offset:3072 lds
    v_and_b32 v1, 31, v0
    v_lshrrev_b32 v2, 5, v0
    v_lshlrev_b32 v3, 2, v1
    v_lshl_add_u32 v251, v2, 9, v3
    s_lshl_b32 s49, s71, 1
    s_add_u32 s48, s74, s49
    s_lshl_b32 s48, s48, 5
    s_lshr_b32 s49, s44, 1
    s_lshl_b32 s49, s49, 3
    s_add_u32 s48, s48, s49
    s_lshl_b32 s64, s48, 10
    s_add_u32 s64, s64, 0x10c0000
    s_add_u32 s65, s64, 4096
    s_lshl_b32 s67, s48, 7
    s_add_u32 s67, s67, 0x12c0000
    s_lshl_b32 s48, s71, 5
    s_add_u32 s48, s48, s49
    v_and_b32 v3, 7, v0
    v_add_u32 v1, s48, v3
    v_lshlrev_b32 v1, 7, v1
    v_add_u32 v254, 0x1460000, v1
    s_and_b32 s48, s44, 6
    s_add_u32 s48, s48, s74
    s_mul_i32 s48, s48, 8704
    s_add_u32 s48, s48, 83968
    v_add_u32 v252, s48, v244
    s_mul_i32 s48, s71, 147456
    s_lshl_b32 s49, s72, 7
    s_add_u32 s100, s48, s49
    s_add_u32 s101, s100, 1152
    v_lshrrev_b32 v1, 3, v0
    s_lshl_b32 s48, s44, 3
    v_add_u32 v2, s48, v1
    v_mul_u32_u24 v2, 2304, v2
    v_lshl_add_u32 v255, v3, 4, v2
    v_mul_u32_u24 v3, 1088, v3
    v_lshl_add_u32 v3, v1, 4, v3
    s_lshr_b32 s48, s44, 2
    s_mul_i32 s48, s48, 8704
    s_lshl_b32 s49, s96, 7
    s_add_u32 s48, s48, s49
    v_add_u32 v253, s48, v3
    s_waitcnt vmcnt(8)
    s_barrier
    s_lshl_b32 s3, s96, 12
    s_add_u32 m0, s3, 0
    s_add_u32 vcc_lo, s98, 1024
    s_add_u32 vcc_hi, s99, 1769472
    buffer_load_dwordx4 v228, s[4:7], vcc_lo offen offset:0 lds
    buffer_load_dwordx4 v229, s[4:7], vcc_lo offen offset:1024 lds
    buffer_load_dwordx4 v230, s[4:7], vcc_lo offen offset:2048 lds
    buffer_load_dwordx4 v231, s[4:7], vcc_lo offen offset:3072 lds
    s_add_u32 m0, s3, 16384
    s_nop 0
    buffer_load_dwordx4 v232, s[8:11], vcc_hi offen offset:0 lds
    buffer_load_dwordx4 v233, s[8:11], vcc_hi offen offset:1024 lds
    buffer_load_dwordx4 v234, s[8:11], vcc_hi offen offset:2048 lds
    buffer_load_dwordx4 v235, s[8:11], vcc_hi offen offset:3072 lds
    s_mul_i32 s48, s96, 5120
    s_add_u32 s48, s48, 102400
    v_and_b32 v1, 31, v0
    v_lshrrev_b32 v2, 5, v0
    v_mul_u32_u24 v3, 80, v1
    v_lshl_add_u32 v3, v2, 3, v3
    v_add_u32 v18, s48, v3
    v_bfe_u32 v3, v0, 2, 2
    v_lshl_add_u32 v5, v2, 2, v3
    v_mul_u32_u24 v5, 80, v5
    v_add_u32 v5, s48, v5
    v_and_b32 v4, 3, v0
    v_lshlrev_b32 v6, 3, v4
    v_and_b32 v3, 1, v0
    v_lshlrev_b32 v3, 3, v3
    v_add_u32 v3, 64, v3
    v_bfe_u32 v4, v0, 4, 1
    v_cmp_eq_u32 vcc, 0, v4
    v_add_u32 v20, v5, v6
    v_mov_b32 v13, 0
    v_cndmask_b32 v6, v3, v6, vcc
    v_mov_b32 v15, 0
    v_add_u32 v19, v5, v6
    s_waitcnt vmcnt(8)
    s_barrier
    s_lshl_b32 s3, s96, 12
    s_add_u32 m0, s3, 32768
    s_add_u32 vcc_lo, s98, 0
    s_add_u32 vcc_hi, s99, 0
    buffer_load_dwordx4 v228, s[12:15], vcc_lo offen offset:0 lds
    buffer_load_dwordx4 v229, s[12:15], vcc_lo offen offset:1024 lds
    buffer_load_dwordx4 v230, s[12:15], vcc_lo offen offset:2048 lds
    buffer_load_dwordx4 v231, s[12:15], vcc_lo offen offset:3072 lds
    s_add_u32 m0, s3, 49152
    s_nop 0
    buffer_load_dwordx4 v232, s[16:19], vcc_hi offen offset:0 lds
    buffer_load_dwordx4 v233, s[16:19], vcc_hi offen offset:1024 lds
    buffer_load_dwordx4 v234, s[16:19], vcc_hi offen offset:2048 lds
    buffer_load_dwordx4 v235, s[16:19], vcc_hi offen offset:3072 lds
    buffer_load_dwordx2 v[170:171], v248, s[36:39], 0 offen sc1
    v_lshl_or_b32 v8, v161, 16, v160
    v_lshl_or_b32 v9, v163, 16, v162
    v_lshl_or_b32 v10, v165, 16, v164
    v_lshl_or_b32 v11, v167, 16, v166
    v_lshl_or_b32 v3, v169, 16, v168
    v_cmp_gt_u32 vcc, 32, v0
    s_nop 1
    v_cndmask_b32 v12, v248, v3, vcc
    v_cndmask_b32 v14, v3, v248, vcc
    s_waitcnt vmcnt(9)
    s_barrier
    s_lshl_b32 s3, s96, 12
    s_add_u32 m0, s3, 65536
    s_add_u32 vcc_lo, s98, 128
    s_add_u32 vcc_hi, s99, 221184
    buffer_load_dwordx4 v228, s[12:15], vcc_lo offen offset:0 lds
    buffer_load_dwordx4 v229, s[12:15], vcc_lo offen offset:1024 lds
    buffer_load_dwordx4 v230, s[12:15], vcc_lo offen offset:2048 lds
    buffer_load_dwordx4 v231, s[12:15], vcc_lo offen offset:3072 lds
    s_add_u32 m0, s3, 81920
    s_nop 0
    buffer_load_dwordx4 v232, s[16:19], vcc_hi offen offset:0 lds
    buffer_load_dwordx4 v233, s[16:19], vcc_hi offen offset:1024 lds
    buffer_load_dwordx4 v234, s[16:19], vcc_hi offen offset:2048 lds
    buffer_load_dwordx4 v235, s[16:19], vcc_hi offen offset:3072 lds
    s_waitcnt vmcnt(8)
L_tok23:
    v_readfirstlane_b32 s48, v171
    v_readfirstlane_b32 s73, v170
    s_cmp_lg_u32 s48, 0
    s_cbranch_scc1 L_tokd24
    buffer_load_dwordx2 v[170:171], v248, s[36:39], 0 offen sc1
    s_waitcnt vmcnt(0)
    s_sleep 1
    s_sub_u32 s76, s76, 1
    s_cbranch_scc0 L_tok23
    s_endpgm
L_tokd24:
    ds_write_b32 v246, v170 offset:40
    s_mov_b32 s54, 32768
    s_waitcnt lgkmcnt(0)
    s_setprio 1
    v_add_u32 v32, s54, v24
    v_add_u32 v33, s54, v25
    v_add_u32 v34, s54, v26
    v_add_u32 v35, s54, v27
    v_add_u32 v36, s54, v28
    v_add_u32 v37, s54, v29
    s_add_u32 s54, s54, 0x8000
    s_and_b32 s54, s54, 0x1ffff
    s_mov_b32 s55, 9
    s_mov_b32 s53, 2
    s_barrier
    s_lshl_b32 s3, s96, 12
    s_add_u32 m0, s3, 98304
    s_add_u32 vcc_lo, s98, 256
    s_add_u32 vcc_hi, s99, 442368
    buffer_load_dwordx4 v228, s[12:15], vcc_lo offen offset:0 lds
    buffer_load_dwordx4 v229, s[12:15], vcc_lo offen offset:1024 lds
    buffer_load_dwordx4 v230, s[12:15], vcc_lo offen offset:2048 lds
    buffer_load_dwordx4 v231, s[12:15], vcc_lo offen offset:3072 lds
    s_add_u32 m0, s3, 114688
    s_nop 0
    buffer_load_dwordx4 v232, s[16:19], vcc_hi offen offset:0 lds
    buffer_load_dwordx4 v233, s[16:19], vcc_hi offen offset:1024 lds
    buffer_load_dwordx4 v234, s[16:19], vcc_hi offen offset:2048 lds
    buffer_load_dwordx4 v235, s[16:19], vcc_hi offen offset:3072 lds
    s_cmp_ge_u32 s45, 9
    s_cbranch_scc1 L_gS0
    s_branch L_gN0
L_lidle:
    s_sub_u32 s48, s74, 28
    s_lshl_b32 s48, s48, 3
    s_add_u32 s48, s48, s44
    v_mul_u32_u24 v1, 1152, v0
    v_mul_u32_u24 v2, 3456, v0
    s_lshr_b32 s52, s75, 1
    s_mul_i32 s52, s52, 589824
    s_and_b32 s53, s75, 1
    s_mul_i32 s53, s53, 1792
L_pf25:
    s_mul_i32 s49, s48, 2979
    s_lshr_b32 s49, s49, 16
    s_mul_i32 s50, s49, 22
    s_sub_u32 s50, s48, s50
    s_cmp_ge_u32 s50, 8
    s_cbranch_scc1 L_pfw26
    s_mul_i32 s50, s50, 73728
    s_lshl_b32 s49, s49, 7
    s_add_u32 s50, s50, s49
    s_add_u32 s50, s50, s52
    buffer_load_dword v3, v1, s[12:15], s50 offen
    s_branch L_pfn27
L_pfw26:
    s_sub_u32 s50, s50, 8
    s_lshl_b32 s50, s50, 7
    s_mul_i32 s49, s49, 221184
    s_add_u32 s50, s50, s49
    s_add_u32 s50, s50, s53
    buffer_load_dword v3, v2, s[16:19], s50 offen
L_pfn27:
    s_add_u32 s48, s48, 32
    s_cmp_lt_u32 s48, 198
    s_cbranch_scc1 L_pf25
    s_waitcnt vmcnt(0)
    s_waitcnt vmcnt(0)
    v_and_b32 v1, 31, v0
    v_lshrrev_b32 v2, 5, v0
    v_lshlrev_b32 v3, 4, v1
    v_lshl_add_u32 v3, v2, 8, v3
    v_add_u32 v3, 1024, v3
    v_subrev_u32 v4, 16, v1
    v_lshlrev_b32 v5, 4, v4
    v_lshl_add_u32 v5, v2, 5, v5
    v_add_u32 v5, 2048, v5
    v_cmp_gt_u32 vcc, 2, v4
    v_add_u32 v6, 64, v5
    v_mov_b32 v7, 0x40000000
    v_cndmask_b32 v5, v7, v5, vcc
    v_cndmask_b32 v6, v7, v6, vcc
    v_and_b32 v4, 27, v1
    v_cmp_eq_u32 vcc, 18, v4
    v_mov_b32 v7, 2176
    s_nop 0
    v_cndmask_b32 v5, v5, v7, vcc
    v_cndmask_b32 v6, v6, v7, vcc
    v_cmp_gt_u32 vcc, 16, v1
    v_add_u32 v4, 512, v3
    s_nop 0
    v_cndmask_b32 v21, v5, v3, vcc
    v_cndmask_b32 v22, v6, v4, vcc
    v_and_b32 v1, 31, v0
    v_lshrrev_b32 v2, 5, v0
    v_cmp_eq_u32 vcc, 20, v1
    v_mov_b32 v3, 17
    v_mov_b32 v4, 0x40000000
    v_cndmask_b32 v3, v1, v3, vcc
    v_cmp_ge_u32 s[48:49], 16, v1
    s_or_b64 vcc, vcc, s[48:49]
    v_lshlrev_b32 v3, 1, v3
    s_mul_i32 s50, s47, 648
    v_cndmask_b32 v3, v4, v3, vcc
    v_mul_u32_u24 v5, 288, v2
    v_add_u32 v4, v3, v5
    s_and_b32 s48, s47, 1
    s_mul_i32 s49, s48, 72
    s_add_u32 s51, s50, s49
    s_mul_i32 s49, s48, 576
    s_sub_u32 s50, s50, s49
    s_add_u32 s50, s50, 576
    buffer_load_ushort v160, v4, s[20:23], s51 offen offset:0
    buffer_load_ushort v161, v4, s[20:23], s51 offen offset:36
    buffer_load_ushort v162, v4, s[20:23], s51 offen offset:72
    buffer_load_ushort v163, v4, s[20:23], s51 offen offset:108
    buffer_load_ushort v164, v4, s[20:23], s51 offen offset:144
    buffer_load_ushort v165, v4, s[20:23], s51 offen offset:180
    buffer_load_ushort v166, v4, s[20:23], s51 offen offset:216
    buffer_load_ushort v167, v4, s[20:23], s51 offen offset:252
    buffer_load_ushort v168, v3, s[20:23], s50 offen
    buffer_load_ushort v169, v3, s[20:23], s50 offen offset:36
    v_lshrrev_b32 v3, 3, v0
    v_bfe_u32 v4, v0, 4, 1
    v_lshlrev_b32 v4, 2, v4
    v_and_b32 v5, 7, v0
    v_xor_b32 v4, v4, v5
    v_mul_u32_u24 v3, 1152, v3
    v_lshl_add_u32 v224, v4, 4, v3
    v_lshrrev_b32 v3, 2, v0
    v_mul_u32_u24 v3, 1152, v3
    v_and_b32 v4, 3, v0
    v_lshl_add_u32 v225, v4, 4, v3
    v_lshrrev_b32 v4, 1, v0
    v_min_u32 v4, 2, v4
    v_and_b32 v5, 1, v0
    s_lshr_b32 s48, s47, 1
    s_mul_i32 s48, s48, 36
    s_and_b32 s49, s47, 1
    s_lshl_b32 s49, s49, 4
    s_add_u32 s48, s48, s49
    v_mul_u32_u24 v3, 576, v4
    v_mul_u32_u24 v6, 19, v5
    v_add3_u32 v3, v3, v6, s48
    v_lshrrev_b32 v3, 7, v3
    s_lshl_b32 s48, s68, 1
    s_add_u32 s48, s48, s78
    v_lshl_add_u32 v3, v3, 4, s48
    v_lshlrev_b32 v3, 7, v3
    v_add_u32 v249, 0x1428000, v3
    s_lshl_b32 s58, s68, 3
    s_lshl_b32 s49, s96, 1
    s_add_u32 s58, s58, s49
    s_lshl_b32 s49, s47, 6
    s_add_u32 s48, s58, s49
    s_lshl_b32 s56, s48, 10
    s_add_u32 s56, s56, 0x740000
    s_mul_i32 s57, s48, 2560
    s_add_u32 s57, s57, 0x980000
    s_lshr_b32 s48, s47, 1
    s_lshl_b32 s48, s48, 6
    s_add_u32 s48, s48, s58
    s_lshl_b32 s48, s48, 8
    s_and_b32 s49, s47, 1
    s_lshl_b32 s49, s49, 2
    s_add_u32 s48, s48, s49
    s_add_u32 s48, s48, 0x940000
    v_mov_b32 v3, s48
    s_bitcmp1_b32 s47, 0
    s_mov_b32 s49, 166144
    s_cselect_b32 s49, 2308, s49
    s_add_u32 s49, s49, s57
    v_mov_b32 v4, s49
    v_mov_b32 v5, 256
    v_mov_b32 v6, 2560
    v_cmp_gt_u32 vcc, 32, v0
    v_and_b32 v1, 31, v0
    v_lshrrev_b32 v2, 5, v0
    v_cndmask_b32 v3, v4, v3, vcc
    v_cndmask_b32 v5, v6, v5, vcc
    v_lshl_add_u32 v16, v1, 3, v3
    v_add_u32 v17, v16, v5
    s_lshl_b32 s59, s45, 4
    s_add_u32 s59, s59, s46
    s_lshl_b32 s59, s59, 7
    s_add_u32 s59, s59, 0x1428000
    s_cmp_lg_u32 s67, 0
    s_cselect_b32 s59, 0x40000000, s59
    s_mul_i32 s48, s96, 5120
    s_add_u32 s48, s48, 102400
    v_and_b32 v1, 31, v0
    v_lshrrev_b32 v2, 5, v0
    v_mul_u32_u24 v3, 80, v1
    v_lshl_add_u32 v3, v2, 3, v3
    v_add_u32 v18, s48, v3
    v_bfe_u32 v3, v0, 2, 2
    v_lshl_add_u32 v5, v2, 2, v3
    v_mul_u32_u24 v5, 80, v5
    v_add_u32 v5, s48, v5
    v_and_b32 v4, 3, v0
    v_lshlrev_b32 v6, 3, v4
    v_and_b32 v3, 1, v0
    v_lshlrev_b32 v3, 3, v3
    v_add_u32 v3, 64, v3
    v_bfe_u32 v4, v0, 4, 1
    v_cmp_eq_u32 vcc, 0, v4
    v_add_u32 v20, v5, v6
    v_mov_b32 v13, 0
    v_cndmask_b32 v6, v3, v6, vcc
    v_mov_b32 v15, 0
    v_add_u32 v19, v5, v6
    s_lshr_b32 s74, s44, 2
    s_xor_b32 s74, s74, s77
    s_and_b32 s3, s72, 5
    s_cmp_eq_u32 s3, s77
    s_cselect_b32 s75, 1, 0
    s_or_b32 s69, s74, 4
    s_cmp_eq_u32 s3, s69
    s_cselect_b32 s69, 1, 0
    s_mul_i32 s50, s78, 18432
    s_add_u32 s50, s50, 102400
    s_mul_i32 s51, s78, 9216
    s_add_u32 s51, s51, 139264
    v_bfe_u32 v2, v0, 2, 2
    v_lshrrev_b32 v3, 5, v0
    v_and_b32 v4, 3, v0
    v_bfe_u32 v5, v0, 4, 1
    v_lshl_add_u32 v4, v5, 2, v4
    v_lshlrev_b32 v4, 3, v4
    v_lshl_add_u32 v2, v3, 2, v2
    v_lshl_add_u32 v240, v2, 6, v4
    v_add_u32 v240, s51, v240
    v_bfe_u32 v5, v0, 3, 1
    v_lshl_add_u32 v4, v5, 6, v4
    v_lshl_add_u32 v236, v2, 7, v4
    v_add_u32 v236, s50, v236
    v_xor_b32 v237, 64, v236
    v_mul_u32_u24 v3, 68, v3
    v_add_u32 v3, 16, v3
    v_lshl_add_u32 v238, v3, 7, v236
    v_lshl_add_u32 v239, v3, 7, v237
    v_lshl_add_u32 v241, v3, 6, v240
    s_lshl_b32 s48, s71, 1
    s_add_u32 s48, s48, s78
    s_lshl_b32 s48, s48, 11
    s_add_u32 s48, s48, 0x1440000
    v_and_b32 v3, 15, v0
    v_lshl_add_u32 v242, v3, 7, s48
    v_and_b32 v3, 7, v0
    s_lshl_b32 s48, s47, 10
    s_add_u32 s48, s48, 0x1430000
    v_lshl_add_u32 v243, v3, 7, s48
    s_mov_b32 s60, 0x1f800000
    s_mov_b32 s61, 0x5f800000
    v_and_b32 v1, 31, v0
    v_lshrrev_b32 v2, 5, v0
    v_lshlrev_b32 v3, 2, v1
    v_lshl_add_u32 v251, v2, 9, v3
    s_lshl_b32 s49, s71, 1
    s_add_u32 s48, s74, s49
    s_lshl_b32 s48, s48, 5
    s_lshr_b32 s49, s44, 1
    s_lshl_b32 s49, s49, 3
    s_add_u32 s48, s48, s49
    s_lshl_b32 s64, s48, 10
    s_add_u32 s64, s64, 0x10c0000
    s_add_u32 s65, s64, 4096
    s_lshl_b32 s67, s48, 7
    s_add_u32 s67, s67, 0x12c0000
    s_lshl_b32 s48, s71, 5
    s_add_u32 s48, s48, s49
    v_and_b32 v3, 7, v0
    v_add_u32 v1, s48, v3
    v_lshlrev_b32 v1, 7, v1
    v_add_u32 v254, 0x1460000, v1
    s_and_b32 s48, s44, 6
    s_add_u32 s48, s48, s74
    s_mul_i32 s48, s48, 8704
    s_add_u32 s48, s48, 83968
    v_add_u32 v252, s48, v244
    s_mul_i32 s48, s71, 147456
    s_lshl_b32 s49, s72, 7
    s_add_u32 s100, s48, s49
    s_add_u32 s101, s100, 1152
    v_lshrrev_b32 v1, 3, v0
    s_lshl_b32 s48, s44, 3
    v_add_u32 v2, s48, v1
    v_mul_u32_u24 v2, 2304, v2
    v_lshl_add_u32 v255, v3, 4, v2
    v_mul_u32_u24 v3, 1088, v3
    v_lshl_add_u32 v3, v1, 4, v3
    s_lshr_b32 s48, s44, 2
    s_mul_i32 s48, s48, 8704
    s_lshl_b32 s49, s96, 7
    s_add_u32 s48, s48, s49
    v_add_u32 v253, s48, v3
    buffer_load_dwordx2 v[170:171], v248, s[36:39], 0 offen sc1
    s_waitcnt vmcnt(0)
    v_lshl_or_b32 v8, v161, 16, v160
    v_lshl_or_b32 v9, v163, 16, v162
    v_lshl_or_b32 v10, v165, 16, v164
    v_lshl_or_b32 v11, v167, 16, v166
    v_lshl_or_b32 v3, v169, 16, v168
    v_cmp_gt_u32 vcc, 32, v0
    s_nop 1
    v_cndmask_b32 v12, v248, v3, vcc
    v_cndmask_b32 v14, v3, v248, vcc
L_tok28:
    v_readfirstlane_b32 s48, v171
    v_readfirstlane_b32 s73, v170
    s_cmp_lg_u32 s48, 0
    s_cbranch_scc1 L_tokd29
    buffer_load_dwordx2 v[170:171], v248, s[36:39], 0 offen sc1
    s_waitcnt vmcnt(0)
    s_sleep 1
    s_sub_u32 s76, s76, 1
    s_cbranch_scc0 L_tok28
    s_endpgm
L_tokd29:
    s_barrier
    ds_write_b32 v246, v170 offset:40
    s_setprio 1
    s_waitcnt lgkmcnt(0)
    s_barrier
    s_branch L_achain
L_achain:
    s_lshl_b32 s99, s72, 7
    s_mul_i32 s3, s96, 9216
    s_add_u32 s99, s99, s3
    s_lshl_b32 s3, s3, 1
    s_and_b32 s98, s72, 2
    s_lshl_b32 s98, s98, 5
    s_add_u32 s98, s98, s3
    s_add_u32 s98, s98, 1024
    s_bitcmp1_b32 s72, 2
    s_cselect_b32 s4, s28, s24
    s_cselect_b32 s5, s29, s25
    s_mov_b32 s6, 663552
    s_mov_b32 s7, 0x20000
    s_mov_b32 s50, 0x3fb8aa3b
    s_mov_b32 s51, 0x3fb8aa3b
    v_mov_b32 v53, 0
    v_mov_b32 v55, 0
    s_waitcnt vmcnt(0)
    s_mov_b64 exec, 1
    ds_add_rtn_u32 v2, v246, v247 offset:4
    s_waitcnt lgkmcnt(0)
    v_readfirstlane_b32 s48, v2
    v_mov_b32 v2, s59
    v_mov_b32 v3, s73
    s_cmp_lg_u32 s48, 3
    s_cbranch_scc1 L_nsig30
    buffer_store_dword v3, v2, s[40:43], 0 offen sc1
L_nsig30:
    s_mov_b64 exec, -1
L_poll31:
    buffer_load_dword v2, v249, s[40:43], 0 offen sc1
    s_waitcnt vmcnt(0)
L_pollc33:
    v_cmp_ne_u32 vcc, s73, v2
    s_cbranch_vccz L_polld32
    s_sleep 4
    s_sub_u32 s76, s76, 1
    s_cbranch_scc0 L_poll31
    s_endpgm
L_polld32:
    buffer_load_dwordx4 v[44:47], v244, s[40:43], s57 offen offset:0 sc1
    buffer_load_dword v52, v16, s[40:43], 0 offen sc1
    buffer_load_dwordx4 v[48:51], v244, s[40:43], s57 offen offset:2560 sc1
    buffer_load_dword v54, v17, s[40:43], 0 offen sc1
    buffer_load_dwordx4 v[36:39], v244, s[40:43], s56 offen offset:0 sc1
    buffer_load_dwordx4 v[40:43], v244, s[40:43], s56 offen offset:1024 sc1
    buffer_load_dwordx4 v[56:59], v21, s[40:43], s57 offen offset:0 sc1
    buffer_load_dwordx4 v[60:63], v22, s[40:43], s57 offen offset:0 sc1
    buffer_load_dwordx4 v[64:67], v21, s[40:43], s57 offen offset:2560 sc1
    buffer_load_dwordx4 v[68:71], v22, s[40:43], s57 offen offset:2560 sc1
L_lw34:
    ds_read_b32 v2, v246 offset:4
    s_waitcnt lgkmcnt(0)
    v_readfirstlane_b32 s48, v2
    s_cmp_ge_u32 s48, 4
    s_cbranch_scc1 L_lwd35
    s_sleep 2
    s_sub_u32 s76, s76, 1
    s_cbranch_scc0 L_lw34
    s_endpgm
L_lwd35:
    s_waitcnt vmcnt(6)
    s_setprio 0
    v_mfma_f32_32x32x8_bf16 v[80:95], v[14:15], v[52:53], 0
    v_mfma_f32_32x32x8_bf16 v[96:111], v[14:15], v[54:55], 0
    v_mfma_f32_32x32x8_bf16 v[112:127], v[12:13], v[52:53], 0
    v_mfma_f32_32x32x8_bf16 v[128:143], v[12:13], v[54:55], 0
    s_nop 6
    v_mfma_f32_32x32x16_bf16 v[80:95], v[8:11], v[44:47], v[80:95]
    v_mfma_f32_32x32x16_bf16 v[96:111], v[8:11], v[48:51], v[96:111]
    s_waitcnt vmcnt(4)
    v_mfma_f32_32x32x16_bf16 v[112:127], v[8:11], v[36:39], v[112:127]
    v_mfma_f32_32x32x16_bf16 v[128:143], v[8:11], v[40:43], v[128:143]
    s_nop 7
    s_setprio 1
    v_pk_mul_f32 v[156:157], v[80:81], s[50:51]
    v_pk_mul_f32 v[158:159], v[82:83], s[50:51]
    v_pk_mul_f32 v[160:161], v[84:85], s[50:51]
    v_pk_mul_f32 v[162:163], v[86:87], s[50:51]
    v_mul_f32 v164, s50, v88
    s_add_u32 s70, s99, 165888
    s_lshl_b32 s3, s96, 10
    s_add_u32 m0, s3, 28672
    s_nop 0
    buffer_load_dwordx4 v224, s[24:27], s70 offen lds
    s_add_u32 m0, s3, 32768
    s_add_u32 s70, s70, 36864
    buffer_load_dwordx4 v224, s[24:27], s70 offen lds
    s_cmp_lg_u32 s96, 2
    s_cbranch_scc1 L_r838
    s_mov_b32 m0, 36864
    s_add_u32 s70, s70, 18432
    buffer_load_dwordx4 v224, s[24:27], s70 offen lds
L_r838:
    s_setprio 0
    v_exp_f32 v144, v156
    v_exp_f32 v145, v157
    v_exp_f32 v146, v158
    v_exp_f32 v147, v159
    v_exp_f32 v148, v160
    v_exp_f32 v149, v161
    v_exp_f32 v150, v162
    v_exp_f32 v151, v163
    v_exp_f32 v152, v164
    s_add_u32 s70, s99, 248832
    s_lshl_b32 s3, s96, 10
    s_add_u32 m0, s3, 37888
    s_nop 0
    buffer_load_dwordx4 v224, s[24:27], s70 offen lds
    s_add_u32 m0, s3, 41984
    s_add_u32 s70, s70, 36864
    buffer_load_dwordx4 v224, s[24:27], s70 offen lds
    s_cmp_lg_u32 s96, 3
    s_cbranch_scc1 L_r839
    s_mov_b32 m0, 46080
    s_add_u32 s70, s70, 9216
    buffer_load_dwordx4 v224, s[24:27], s70 offen lds
L_r839:
    v_exp_f32 v156, -v156
    v_exp_f32 v157, -v157
    v_exp_f32 v158, -v158
    v_exp_f32 v159, -v159
    v_exp_f32 v160, -v160
    v_exp_f32 v161, -v161
    v_exp_f32 v162, -v162
    v_exp_f32 v163, -v163
    v_exp_f32 v164, -v164
    s_setprio 1
    s_add_u32 s70, s99, 497664
    s_lshl_b32 s3, s96, 10
    s_add_u32 m0, s3, 47104
    s_nop 0
    buffer_load_dwordx4 v224, s[24:27], s70 offen lds
    s_add_u32 m0, s3, 51200
    s_add_u32 s70, s70, 36864
    buffer_load_dwordx4 v224, s[24:27], s70 offen lds
    s_cmp_lg_u32 s96, 2
    s_cbranch_scc1 L_r840
    s_mov_b32 m0, 55296
    s_add_u32 s70, s70, 18432
    buffer_load_dwordx4 v224, s[24:27], s70 offen lds
L_r840:
    v_pk_add_f32 v[2:3], v[144:145], v[146:147]
    v_pk_add_f32 v[4:5], v[156:157], v[158:159]
    v_pk_add_f32 v[2:3], v[2:3], v[148:149]
    v_pk_add_f32 v[4:5], v[4:5], v[160:161]
    v_pk_add_f32 v[2:3], v[2:3], v[150:151]
    v_pk_add_f32 v[4:5], v[4:5], v[162:163]
    v_add_f32 v2, v2, v152
    v_add_f32 v4, v4, v164
    v_add_f32 v2, v2, v3
    v_add_f32 v4, v4, v5
    s_nop 1
    v_permlane32_swap_b32 v2, v4
    v_add_f32 v2, v2, v4
    v_cmp_nle_f32 s[62:63], s60, v2
    v_cmp_nge_f32 vcc, s61, v2
    s_or_b64 vcc, vcc, s[62:63]
    s_cbranch_scc1 L_smx36
L_smb37:
    v_rcp_f32 v2, v2
    s_nop 0
    v_mov_b32 v4, v2
    s_nop 1
    v_permlane32_swap_b32 v2, v4
    v_pk_mul_f32 v[144:145], v[144:145], v[2:3] op_sel_hi:[1,0]
    v_pk_mul_f32 v[146:147], v[146:147], v[2:3] op_sel_hi:[1,0]
    v_pk_mul_f32 v[148:149], v[148:149], v[2:3] op_sel_hi:[1,0]
    v_pk_mul_f32 v[150:151], v[150:151], v[2:3] op_sel_hi:[1,0]
    v_mul_f32 v152, v152, v2
    v_pk_mul_f32 v[156:157], v[156:157], v[4:5] op_sel_hi:[1,0]
    v_pk_mul_f32 v[158:159], v[158:159], v[4:5] op_sel_hi:[1,0]
    v_pk_mul_f32 v[160:161], v[160:161], v[4:5] op_sel_hi:[1,0]
    v_pk_mul_f32 v[162:163], v[162:163], v[4:5] op_sel_hi:[1,0]
    v_mul_f32 v164, v164, v4
    s_add_u32 s70, s99, 580608
    s_lshl_b32 s3, s96, 10
    s_add_u32 m0, s3, 56320
    s_nop 0
    buffer_load_dwordx4 v224, s[24:27], s70 offen lds
    s_add_u32 m0, s3, 60416
    s_add_u32 s70, s70, 36864
    buffer_load_dwordx4 v224, s[24:27], s70 offen lds
    s_cmp_lg_u32 s96, 3
    s_cbranch_scc1 L_r841
    s_mov_b32 m0, 64512
    s_add_u32 s70, s70, 9216
    buffer_load_dwordx4 v224, s[24:27], s70 offen lds
L_r841:
    v_cvt_pk_bf16_f32 v168, v144, v145
    v_cvt_pk_bf16_f32 v169, v146, v147
    v_cvt_pk_bf16_f32 v170, v148, v149
    v_cvt_pk_bf16_f32 v171, v150, v151
    v_cvt_pk_bf16_f32 v172, v156, v157
    v_cvt_pk_bf16_f32 v173, v158, v159
    v_cvt_pk_bf16_f32 v174, v160, v161
    v_cvt_pk_bf16_f32 v175, v162, v163
    v_cvt_pk_bf16_f32 v176, v152, v164
    ds_write_b64 v18, v[168:169] offset:0
    ds_write_b64 v18, v[170:171] offset:16
    ds_write_b64 v18, v[172:173] offset:32
    ds_write_b64 v18, v[174:175] offset:48
    ds_write_b32 v18, v176 offset:64
    v_pk_mul_f32 v[156:157], v[96:97], s[50:51]
    v_pk_mul_f32 v[158:159], v[98:99], s[50:51]
    v_pk_mul_f32 v[160:161], v[100:101], s[50:51]
    v_pk_mul_f32 v[162:163], v[102:103], s[50:51]
    v_mul_f32 v164, s50, v104
    s_add_u32 s70, s99, 0
    s_lshl_b32 s3, s96, 10
    s_add_u32 m0, s3, 83968
    s_nop 0
    buffer_load_dwordx4 v224, s[28:31], s70 offen lds
    s_add_u32 m0, s3, 88064
    s_add_u32 s70, s70, 36864
    buffer_load_dwordx4 v224, s[28:31], s70 offen lds
    s_cmp_lg_u32 s96, 0
    s_cbranch_scc1 L_r844
    s_mov_b32 m0, 92160
    s_add_u32 s70, s70, 36864
    buffer_load_dwordx4 v224, s[28:31], s70 offen lds
L_r844:
    v_exp_f32 v144, v156
    v_exp_f32 v145, v157
    v_exp_f32 v146, v158
    v_exp_f32 v147, v159
    v_exp_f32 v148, v160
    v_exp_f32 v149, v161
    v_exp_f32 v150, v162
    v_exp_f32 v151, v163
    v_exp_f32 v152, v164
    s_add_u32 s70, s99, 82944
    s_lshl_b32 s3, s96, 10
    s_add_u32 m0, s3, 93184
    s_nop 0
    buffer_load_dwordx4 v224, s[28:31], s70 offen lds
    s_add_u32 m0, s3, 97280
    s_add_u32 s70, s70, 36864
    buffer_load_dwordx4 v224, s[28:31], s70 offen lds
    s_cmp_lg_u32 s96, 1
    s_cbranch_scc1 L_r845
    s_mov_b32 m0, 101376
    s_add_u32 s70, s70, 27648
    buffer_load_dwordx4 v224, s[28:31], s70 offen lds
L_r845:
    v_exp_f32 v156, -v156
    v_exp_f32 v157, -v157
    v_exp_f32 v158, -v158
    v_exp_f32 v159, -v159
    v_exp_f32 v160, -v160
    v_exp_f32 v161, -v161
    v_exp_f32 v162, -v162
    v_exp_f32 v163, -v163
    v_exp_f32 v164, -v164
    s_bitcmp1_b32 s72, 2
    s_mov_b32 s70, 165888
    s_cselect_b32 s70, 0, s70
    s_add_u32 s70, s70, s98
    s_lshl_b32 s3, s96, 10
    s_add_u32 m0, s3, 65536
    s_nop 0
    buffer_load_dwordx4 v225, s[4:7], s70 offen lds
    s_add_u32 m0, s3, 69632
    s_add_u32 s70, s70, 73728
    buffer_load_dwordx4 v225, s[4:7], s70 offen lds
    s_cmp_lg_u32 s96, 2
    s_cbranch_scc1 L_r846
    s_mov_b32 m0, 73728
    s_add_u32 s70, s70, 36864
    buffer_load_dwordx4 v225, s[4:7], s70 offen lds
L_r846:
    v_pk_add_f32 v[2:3], v[144:145], v[146:147]
    v_pk_add_f32 v[4:5], v[156:157], v[158:159]
    v_pk_add_f32 v[2:3], v[2:3], v[148:149]
    v_pk_add_f32 v[4:5], v[4:5], v[160:161]
    v_pk_add_f32 v[2:3], v[2:3], v[150:151]
    v_pk_add_f32 v[4:5], v[4:5], v[162:163]
    v_add_f32 v2, v2, v152
    v_add_f32 v4, v4, v164
    v_add_f32 v2, v2, v3
    v_add_f32 v4, v4, v5
    s_nop 1
    v_permlane32_swap_b32 v2, v4
    v_add_f32 v2, v2, v4
    v_cmp_nle_f32 s[62:63], s60, v2
    v_cmp_nge_f32 vcc, s61, v2
    s_or_b64 vcc, vcc, s[62:63]
    s_cbranch_scc1 L_smx42
L_smb43:
    v_rcp_f32 v2, v2
    s_nop 0
    v_mov_b32 v4, v2
    s_nop 1
    v_permlane32_swap_b32 v2, v4
    v_pk_mul_f32 v[144:145], v[144:145], v[2:3] op_sel_hi:[1,0]
    v_pk_mul_f32 v[146:147], v[146:147], v[2:3] op_sel_hi:[1,0]
    v_pk_mul_f32 v[148:149], v[148:149], v[2:3] op_sel_hi:[1,0]
    v_pk_mul_f32 v[150:151], v[150:151], v[2:3] op_sel_hi:[1,0]
    v_mul_f32 v152, v152, v2
    v_pk_mul_f32 v[156:157], v[156:157], v[4:5] op_sel_hi:[1,0]
    v_pk_mul_f32 v[158:159], v[158:159], v[4:5] op_sel_hi:[1,0]
    v_pk_mul_f32 v[160:161], v[160:161], v[4:5] op_sel_hi:[1,0]
    v_pk_mul_f32 v[162:163], v[162:163], v[4:5] op_sel_hi:[1,0]
    v_mul_f32 v164, v164, v4
    s_bitcmp1_b32 s72, 2
    s_mov_b32 s70, 497664
    s_cselect_b32 s70, 165888, s70
    s_add_u32 s70, s70, s98
    s_lshl_b32 s3, s96, 10
    s_add_u32 m0, s3, 74752
    s_nop 0
    buffer_load_dwordx4 v225, s[4:7], s70 offen lds
    s_add_u32 m0, s3, 78848
    s_add_u32 s70, s70, 73728
    buffer_load_dwordx4 v225, s[4:7], s70 offen lds
    s_cmp_lg_u32 s96, 3
    s_cbranch_scc1 L_r847
    s_mov_b32 m0, 82944
    s_add_u32 s70, s70, 18432
    buffer_load_dwordx4 v225, s[4:7], s70 offen lds
L_r847:
    v_cvt_pk_bf16_f32 v178, v144, v145
    v_cvt_pk_bf16_f32 v179, v146, v147
    v_cvt_pk_bf16_f32 v180, v148, v149
    v_cvt_pk_bf16_f32 v181, v150, v151
    v_cvt_pk_bf16_f32 v182, v156, v157
    v_cvt_pk_bf16_f32 v183, v158, v159
    v_cvt_pk_bf16_f32 v184, v160, v161
    v_cvt_pk_bf16_f32 v185, v162, v163
    v_cvt_pk_bf16_f32 v186, v152, v164
    ds_write_b64 v18, v[178:179] offset:2560
    ds_write_b64 v18, v[180:181] offset:2576
    ds_write_b64 v18, v[182:183] offset:2592
    ds_write_b64 v18, v[184:185] offset:2608
    ds_write_b32 v18, v186 offset:2624
    s_waitcnt lgkmcnt(0)
    ds_read_b64_tr_b16 v[144:145], v19 offset:0
    ds_read_b64_tr_b16 v[146:147], v19 offset:640
    ds_read_b64_tr_b16 v[148:149], v20 offset:32
    ds_read_b64_tr_b16 v[150:151], v20 offset:672
    ds_read_b64_tr_b16 v[152:153], v19 offset:1280
    ds_read_b64_tr_b16 v[154:155], v19 offset:1920
    ds_read_b64_tr_b16 v[156:157], v20 offset:1312
    ds_read_b64_tr_b16 v[158:159], v20 offset:1952
    ds_read_b64_tr_b16 v[160:161], v19 offset:2560
    ds_read_b64_tr_b16 v[162:163], v19 offset:3200
    ds_read_b64_tr_b16 v[164:165], v20 offset:2592
    ds_read_b64_tr_b16 v[166:167], v20 offset:3232
    ds_read_b64_tr_b16 v[168:169], v19 offset:3840
    ds_read_b64_tr_b16 v[170:171], v19 offset:4480
    ds_read_b64_tr_b16 v[172:173], v20 offset:3872
    ds_read_b64_tr_b16 v[174:175], v20 offset:4512
    s_mul_i32 s48, s96, 5120
    s_add_u32 s48, s48, 102400
    v_add_u32 v6, s48, v244
    v_lshlrev_b32 v1, 3, v0
    v_add_u32 v7, s48, v1
    s_waitcnt vmcnt(16) lgkmcnt(0)
    s_setprio 0
    v_mfma_f32_32x32x16_bf16 v[80:95], v[144:147], v[56:59], 0
    v_mfma_f32_32x32x16_bf16 v[96:111], v[148:151], v[56:59], 0
    v_mfma_f32_32x32x16_bf16 v[80:95], v[152:155], v[60:63], v[80:95]
    v_mfma_f32_32x32x16_bf16 v[96:111], v[156:159], v[60:63], v[96:111]
    v_mfma_f32_32x32x16_bf16 v[80:95], v[160:163], v[64:67], v[80:95]
    v_mfma_f32_32x32x16_bf16 v[96:111], v[164:167], v[64:67], v[96:111]
    v_mfma_f32_32x32x16_bf16 v[80:95], v[168:171], v[68:71], v[80:95]
    v_mfma_f32_32x32x16_bf16 v[96:111], v[172:175], v[68:71], v[96:111]
    s_nop 10
    s_setprio 1
    ds_write_b128 v6, v[80:83]
    ds_write_b128 v6, v[84:87] offset:1024
    ds_write_b64 v7, v[88:89] offset:2048
    ds_write_b128 v6, v[96:99] offset:2560
    ds_write_b128 v6, v[100:103] offset:3584
    s_waitcnt lgkmcnt(0)
    s_mov_b64 exec, 1
    ds_add_u32 v246, v247 offset:8
    s_mov_b64 exec, -1
    s_mul_i32 s55, s77, 2560
    s_lshl_b32 s49, s78, 10
    s_add_u32 s55, s55, s49
    s_add_u32 s49, s55, 102400
    v_add_u32 v6, s49, v244
    v_add_u32 v7, 102400, v1
    s_lshl_b32 s48, s47, 3
    s_add_u32 s49, s48, s68
    s_mul_i32 s52, s49, 4608
    s_add_u32 s52, s52, 0x1300000
    s_add_u32 s53, s52, s55
    s_lshl_b32 s49, s49, 7
    s_add_u32 s49, s49, 0x1430000
L_lw48:
    ds_read_b32 v2, v246 offset:8
    s_waitcnt lgkmcnt(0)
    v_readfirstlane_b32 s48, v2
    s_cmp_ge_u32 s48, 4
    s_cbranch_scc1 L_lwd49
    s_sleep 2
    s_sub_u32 s76, s76, 1
    s_cbranch_scc0 L_lw48
    s_endpgm
L_lwd49:
    ds_read_b128 v[80:83], v6 offset:0
    ds_read_b128 v[84:87], v6 offset:5120
    ds_read_b128 v[88:91], v6 offset:10240
    ds_read_b128 v[92:95], v6 offset:15360
    s_cmp_lg_u32 s96, 3
    s_cbranch_scc1 L_kvx
    ds_read_b64 v[96:97], v7 offset:2048
    ds_read_b64 v[98:99], v7 offset:7168
    ds_read_b64 v[100:101], v7 offset:12288
    ds_read_b64 v[102:103], v7 offset:17408
    s_waitcnt lgkmcnt(0)
    v_pk_add_f32 v[96:97], v[96:97], v[98:99]
    v_pk_add_f32 v[96:97], v[96:97], v[100:101]
    v_pk_add_f32 v[96:97], v[96:97], v[102:103]
    buffer_store_dwordx2 v[96:97], v1, s[40:43], s52 offen offset:2048 sc1
L_kvx:
    s_waitcnt lgkmcnt(0)
    v_pk_add_f32 v[80:81], v[80:81], v[84:85]
    v_pk_add_f32 v[82:83], v[82:83], v[86:87]
    v_pk_add_f32 v[80:81], v[80:81], v[88:89]
    v_pk_add_f32 v[82:83], v[82:83], v[90:91]
    v_pk_add_f32 v[80:81], v[80:81], v[92:93]
    v_pk_add_f32 v[82:83], v[82:83], v[94:95]
    buffer_store_dwordx4 v[80:83], v244, s[40:43], s53 offen sc1
    s_waitcnt vmcnt(0)
    s_mov_b64 exec, 1
    ds_add_rtn_u32 v2, v246, v247 offset:12
    s_waitcnt lgkmcnt(0)
    v_readfirstlane_b32 s48, v2
    v_mov_b32 v2, s49
    v_mov_b32 v3, s73
    s_cmp_lg_u32 s48, 3
    s_cbranch_scc1 L_nsig50
    buffer_store_dword v3, v2, s[40:43], 0 offen sc1
L_nsig50:
    s_mov_b64 exec, -1
    s_lshl_b32 s48, s47, 3
    s_mul_i32 s52, s48, 4608
    s_add_u32 s52, s52, 0x1300000
    s_add_u32 s53, s52, s55
    s_lshl_b32 s55, s77, 10
    s_lshl_b32 s48, s78, 3
    s_add_u32 s55, s55, s48
    s_add_u32 s55, s55, 157952
L_lw51:
    ds_read_b32 v2, v246 offset:12
    s_waitcnt lgkmcnt(0)
    v_readfirstlane_b32 s48, v2
    s_cmp_ge_u32 s48, 4
    s_cbranch_scc1 L_lwd52
    s_sleep 2
    s_sub_u32 s76, s76, 1
    s_cbranch_scc0 L_lw51
    s_endpgm
L_lwd52:
    v_pk_mul_f32 v[156:157], v[112:113], s[50:51]
    v_pk_mul_f32 v[158:159], v[114:115], s[50:51]
    v_pk_mul_f32 v[160:161], v[116:117], s[50:51]
    v_pk_mul_f32 v[162:163], v[118:119], s[50:51]
    v_mul_f32 v164, s50, v120
    s_add_u32 s70, s99, 0
    s_lshl_b32 s3, s96, 10
    s_add_u32 m0, s3, 102400
    s_nop 0
    buffer_load_dwordx4 v224, s[24:27], s70 offen lds
    s_add_u32 m0, s3, 106496
    s_add_u32 s70, s70, 36864
    buffer_load_dwordx4 v224, s[24:27], s70 offen lds
    s_cmp_lg_u32 s96, 0
    s_cbranch_scc1 L_r855
    s_mov_b32 m0, 110592
    s_add_u32 s70, s70, 36864
    buffer_load_dwordx4 v224, s[24:27], s70 offen lds
L_r855:
    s_setprio 0
    v_exp_f32 v144, v156
    v_exp_f32 v145, v157
    v_exp_f32 v146, v158
    v_exp_f32 v147, v159
    v_exp_f32 v148, v160
    v_exp_f32 v149, v161
    v_exp_f32 v150, v162
    v_exp_f32 v151, v163
    v_exp_f32 v152, v164
    s_add_u32 s70, s99, 82944
    s_lshl_b32 s3, s96, 10
    s_add_u32 m0, s3, 111616
    s_nop 0
    buffer_load_dwordx4 v224, s[24:27], s70 offen lds
    s_add_u32 m0, s3, 115712
    s_add_u32 s70, s70, 36864
    buffer_load_dwordx4 v224, s[24:27], s70 offen lds
    s_cmp_lg_u32 s96, 1
    s_cbranch_scc1 L_r856
    s_mov_b32 m0, 119808
    s_add_u32 s70, s70, 27648
    buffer_load_dwordx4 v224, s[24:27], s70 offen lds
L_r856:
    v_exp_f32 v156, -v156
    v_exp_f32 v157, -v157
    v_exp_f32 v158, -v158
    v_exp_f32 v159, -v159
    v_exp_f32 v160, -v160
    v_exp_f32 v161, -v161
    v_exp_f32 v162, -v162
    v_exp_f32 v163, -v163
    v_exp_f32 v164, -v164
    s_setprio 1
    s_add_u32 s70, s99, 331776
    s_lshl_b32 s3, s96, 10
    s_add_u32 m0, s3, 120832
    s_nop 0
    buffer_load_dwordx4 v224, s[24:27], s70 offen lds
    s_add_u32 m0, s3, 124928
    s_add_u32 s70, s70, 36864
    buffer_load_dwordx4 v224, s[24:27], s70 offen lds
    s_cmp_lg_u32 s96, 0
    s_cbranch_scc1 L_r857
    s_mov_b32 m0, 129024
    s_add_u32 s70, s70, 36864
    buffer_load_dwordx4 v224, s[24:27], s70 offen lds
L_r857:
    v_pk_add_f32 v[2:3], v[144:145], v[146:147]
    v_pk_add_f32 v[4:5], v[156:157], v[158:159]
    v_pk_add_f32 v[2:3], v[2:3], v[148:149]
    v_pk_add_f32 v[4:5], v[4:5], v[160:161]
    v_pk_add_f32 v[2:3], v[2:3], v[150:151]
    v_pk_add_f32 v[4:5], v[4:5], v[162:163]
    v_add_f32 v2, v2, v152
    v_add_f32 v4, v4, v164
    v_add_f32 v2, v2, v3
    v_add_f32 v4, v4, v5
    s_nop 1
    v_permlane32_swap_b32 v2, v4
    v_add_f32 v2, v2, v4
    v_cmp_nle_f32 s[62:63], s60, v2
    v_cmp_nge_f32 vcc, s61, v2
    s_or_b64 vcc, vcc, s[62:63]
    s_cbranch_scc1 L_smx53
L_smb54:
    v_rcp_f32 v2, v2
    s_nop 0
    v_mov_b32 v4, v2
    s_nop 1
    v_permlane32_swap_b32 v2, v4
    v_pk_mul_f32 v[144:145], v[144:145], v[2:3] op_sel_hi:[1,0]
    v_pk_mul_f32 v[146:147], v[146:147], v[2:3] op_sel_hi:[1,0]
    v_pk_mul_f32 v[148:149], v[148:149], v[2:3] op_sel_hi:[1,0]
    v_pk_mul_f32 v[150:151], v[150:151], v[2:3] op_sel_hi:[1,0]
    v_mul_f32 v152, v152, v2
    v_pk_mul_f32 v[156:157], v[156:157], v[4:5] op_sel_hi:[1,0]
    v_pk_mul_f32 v[158:159], v[158:159], v[4:5] op_sel_hi:[1,0]
    v_pk_mul_f32 v[160:161], v[160:161], v[4:5] op_sel_hi:[1,0]
    v_pk_mul_f32 v[162:163], v[162:163], v[4:5] op_sel_hi:[1,0]
    v_mul_f32 v164, v164, v4
    s_add_u32 s70, s99, 414720
    s_lshl_b32 s3, s96, 10
    s_add_u32 m0, s3, 130048
    s_nop 0
    buffer_load_dwordx4 v224, s[24:27], s70 offen lds
    s_add_u32 m0, s3, 134144
    s_add_u32 s70, s70, 36864
    buffer_load_dwordx4 v224, s[24:27], s70 offen lds
    s_cmp_lg_u32 s96, 1
    s_cbranch_scc1 L_r858
    s_mov_b32 m0, 138240
    s_add_u32 s70, s70, 27648
    buffer_load_dwordx4 v224, s[24:27], s70 offen lds
L_r858:
    v_cvt_pk_bf16_f32 v204, v144, v145
    v_cvt_pk_bf16_f32 v205, v146, v147
    v_cvt_pk_bf16_f32 v206, v148, v149
    v_cvt_pk_bf16_f32 v207, v150, v151
    v_cvt_pk_bf16_f32 v208, v156, v157
    v_cvt_pk_bf16_f32 v209, v158, v159
    v_cvt_pk_bf16_f32 v210, v160, v161
    v_cvt_pk_bf16_f32 v211, v162, v163
    v_cvt_pk_bf16_f32 v212, v152, v164
    v_mov_b32 v213, 0
    v_pk_mul_f32 v[156:157], v[128:129], s[50:51]
    v_pk_mul_f32 v[158:159], v[130:131], s[50:51]
    v_pk_mul_f32 v[160:161], v[132:133], s[50:51]
    v_pk_mul_f32 v[162:163], v[134:135], s[50:51]
    v_mul_f32 v164, s50, v136
    s_bitcmp1_b32 s72, 2
    s_mov_b32 s70, 0
    s_cselect_b32 s70, 331776, s70
    s_add_u32 s70, s70, s98
    s_lshl_b32 s3, s96, 10
    s_add_u32 m0, s3, 139264
    s_nop 0
    buffer_load_dwordx4 v225, s[4:7], s70 offen lds
    s_add_u32 m0, s3, 143360
    s_add_u32 s70, s70, 73728
    buffer_load_dwordx4 v225, s[4:7], s70 offen lds
    s_cmp_lg_u32 s96, 0
    s_cbranch_scc1 L_r861
    s_mov_b32 m0, 147456
    s_add_u32 s70, s70, 73728
    buffer_load_dwordx4 v225, s[4:7], s70 offen lds
L_r861:
    s_setprio 0
    v_exp_f32 v144, v156
    v_exp_f32 v145, v157
    v_exp_f32 v146, v158
    v_exp_f32 v147, v159
    v_exp_f32 v148, v160
    v_exp_f32 v149, v161
    v_exp_f32 v150, v162
    v_exp_f32 v151, v163
    v_exp_f32 v152, v164
    s_bitcmp1_b32 s72, 2
    s_mov_b32 s70, 331776
    s_cselect_b32 s70, 497664, s70
    s_add_u32 s70, s70, s98
    s_lshl_b32 s3, s96, 10
    s_add_u32 m0, s3, 148480
    s_nop 0
    buffer_load_dwordx4 v225, s[4:7], s70 offen lds
    s_add_u32 m0, s3, 152576
    s_add_u32 s70, s70, 73728
    buffer_load_dwordx4 v225, s[4:7], s70 offen lds
    s_cmp_lg_u32 s96, 1
    s_cbranch_scc1 L_r862
    s_mov_b32 m0, 156672
    s_add_u32 s70, s70, 55296
    buffer_load_dwordx4 v225, s[4:7], s70 offen lds
L_r862:
    v_exp_f32 v156, -v156
    v_exp_f32 v157, -v157
    v_exp_f32 v158, -v158
    v_exp_f32 v159, -v159
    v_exp_f32 v160, -v160
    v_exp_f32 v161, -v161
    v_exp_f32 v162, -v162
    v_exp_f32 v163, -v163
    v_exp_f32 v164, -v164
    s_setprio 1
    v_pk_add_f32 v[2:3], v[144:145], v[146:147]
    v_pk_add_f32 v[4:5], v[156:157], v[158:159]
    v_pk_add_f32 v[2:3], v[2:3], v[148:149]
    v_pk_add_f32 v[4:5], v[4:5], v[160:161]
    v_pk_add_f32 v[2:3], v[2:3], v[150:151]
    v_pk_add_f32 v[4:5], v[4:5], v[162:163]
    v_add_f32 v2, v2, v152
    v_add_f32 v4, v4, v164
    v_add_f32 v2, v2, v3
    v_add_f32 v4, v4, v5
    s_nop 1
    v_permlane32_swap_b32 v2, v4
    v_add_f32 v2, v2, v4
    v_cmp_nle_f32 s[62:63], s60, v2
    v_cmp_nge_f32 vcc, s61, v2
    s_or_b64 vcc, vcc, s[62:63]
    s_cbranch_scc1 L_smx59
L_smb60:
    v_rcp_f32 v2, v2
    s_nop 0
    v_mov_b32 v4, v2
    s_nop 1
    v_permlane32_swap_b32 v2, v4
    v_pk_mul_f32 v[144:145], v[144:145], v[2:3] op_sel_hi:[1,0]
    v_pk_mul_f32 v[146:147], v[146:147], v[2:3] op_sel_hi:[1,0]
    v_pk_mul_f32 v[148:149], v[148:149], v[2:3] op_sel_hi:[1,0]
    v_pk_mul_f32 v[150:151], v[150:151], v[2:3] op_sel_hi:[1,0]
    v_mul_f32 v152, v152, v2
    v_pk_mul_f32 v[156:157], v[156:157], v[4:5] op_sel_hi:[1,0]
    v_pk_mul_f32 v[158:159], v[158:159], v[4:5] op_sel_hi:[1,0]
    v_pk_mul_f32 v[160:161], v[160:161], v[4:5] op_sel_hi:[1,0]
    v_pk_mul_f32 v[162:163], v[162:163], v[4:5] op_sel_hi:[1,0]
    v_mul_f32 v164, v164, v4
    v_cvt_pk_bf16_f32 v214, v144, v145
    v_cvt_pk_bf16_f32 v215, v146, v147
    v_cvt_pk_bf16_f32 v216, v148, v149
    v_cvt_pk_bf16_f32 v217, v150, v151
    v_cvt_pk_bf16_f32 v218, v156, v157
    v_cvt_pk_bf16_f32 v219, v158, v159
    v_cvt_pk_bf16_f32 v220, v160, v161
    v_cvt_pk_bf16_f32 v221, v162, v163
    v_cvt_pk_bf16_f32 v222, v152, v164
    v_mov_b32 v223, 0
L_poll63:
    buffer_load_dword v2, v243, s[40:43], 0 offen sc1
    s_waitcnt vmcnt(0)
L_pollc65:
    v_cmp_ne_u32 vcc, s73, v2
    s_cbranch_vccz L_polld64
    s_sleep 4
    s_sub_u32 s76, s76, 1
    s_cbranch_scc0 L_poll63
    s_endpgm
L_polld64:
    buffer_load_dwordx4 v[80:83], v244, s[40:43], s53 offen sc1
    s_add_u32 s53, s53, 4608
    buffer_load_dwordx4 v[84:87], v244, s[40:43], s53 offen sc1
    s_add_u32 s53, s53, 4608
    buffer_load_dwordx4 v[88:91], v244, s[40:43], s53 offen sc1
    s_add_u32 s53, s53, 4608
    buffer_load_dwordx4 v[92:95], v244, s[40:43], s53 offen sc1
    s_add_u32 s53, s53, 4608
    buffer_load_dwordx4 v[96:99], v244, s[40:43], s53 offen sc1
    s_add_u32 s53, s53, 4608
    buffer_load_dwordx4 v[100:103], v244, s[40:43], s53 offen sc1
    s_add_u32 s53, s53, 4608
    buffer_load_dwordx4 v[104:107], v244, s[40:43], s53 offen sc1
    s_add_u32 s53, s53, 4608
    buffer_load_dwordx4 v[108:111], v244, s[40:43], s53 offen sc1
    v_add_u32 v3, s55, v244
    v_add_u32 v6, 160000, v1
    s_cmp_lg_u32 s96, 3
    s_cbranch_scc1 L_kvs
    buffer_load_dwordx2 v[112:113], v1, s[40:43], s52 offen offset:2048 sc1
    s_add_u32 s52, s52, 4608
    buffer_load_dwordx2 v[114:115], v1, s[40:43], s52 offen offset:2048 sc1
    s_add_u32 s52, s52, 4608
    buffer_load_dwordx2 v[116:117], v1, s[40:43], s52 offen offset:2048 sc1
    s_add_u32 s52, s52, 4608
    buffer_load_dwordx2 v[118:119], v1, s[40:43], s52 offen offset:2048 sc1
    s_add_u32 s52, s52, 4608
    buffer_load_dwordx2 v[120:121], v1, s[40:43], s52 offen offset:2048 sc1
    s_add_u32 s52, s52, 4608
    buffer_load_dwordx2 v[122:123], v1, s[40:43], s52 offen offset:2048 sc1
    s_add_u32 s52, s52, 4608
    buffer_load_dwordx2 v[124:125], v1, s[40:43], s52 offen offset:2048 sc1
    s_add_u32 s52, s52, 4608
    buffer_load_dwordx2 v[126:127], v1, s[40:43], s52 offen offset:2048 sc1
    s_waitcnt vmcnt(0)
    v_pk_add_f32 v[112:113], v[112:113], v[114:115]
    v_pk_add_f32 v[112:113], v[112:113], v[116:117]
    v_pk_add_f32 v[112:113], v[112:113], v[118:119]
    v_pk_add_f32 v[112:113], v[112:113], v[120:121]
    v_pk_add_f32 v[112:113], v[112:113], v[122:123]
    v_pk_add_f32 v[112:113], v[112:113], v[124:125]
    v_pk_add_f32 v[112:113], v[112:113], v[126:127]
    v_cvt_pk_bf16_f32 v4, v112, v113
    v_mov_b32 v5, 0
    ds_write_b64 v6, v[4:5]
L_kvs:
    s_waitcnt vmcnt(0)
    v_pk_add_f32 v[80:81], v[80:81], v[84:85]
    v_pk_add_f32 v[82:83], v[82:83], v[86:87]
    v_pk_add_f32 v[80:81], v[80:81], v[88:89]
    v_pk_add_f32 v[82:83], v[82:83], v[90:91]
    v_pk_add_f32 v[80:81], v[80:81], v[92:93]
    v_pk_add_f32 v[82:83], v[82:83], v[94:95]
    v_pk_add_f32 v[80:81], v[80:81], v[96:97]
    v_pk_add_f32 v[82:83], v[82:83], v[98:99]
    v_pk_add_f32 v[80:81], v[80:81], v[100:101]
    v_pk_add_f32 v[82:83], v[82:83], v[102:103]
    v_pk_add_f32 v[80:81], v[80:81], v[104:105]
    v_pk_add_f32 v[82:83], v[82:83], v[106:107]
    v_pk_add_f32 v[80:81], v[80:81], v[108:109]
    v_pk_add_f32 v[82:83], v[82:83], v[110:111]
    v_cvt_pk_bf16_f32 v10, v80, v81
    v_cvt_pk_bf16_f32 v11, v82, v83
    ds_write_b64 v3, v[10:11]
    s_waitcnt lgkmcnt(0)
    s_mov_b64 exec, 1
    ds_add_u32 v246, v247 offset:16
    s_mov_b64 exec, -1
L_lw66:
    ds_read_b32 v2, v246 offset:16
    s_waitcnt lgkmcnt(0)
    v_readfirstlane_b32 s48, v2
    s_cmp_ge_u32 s48, 4
    s_cbranch_scc1 L_lwd67
    s_sleep 2
    s_sub_u32 s76, s76, 1
    s_cbranch_scc0 L_lw66
    s_endpgm
L_lwd67:
    v_add_u32 v3, 157952, v244
    ds_read_b64 v[152:153], v6
    ds_read_b128 v[144:147], v3
    ds_read_b128 v[148:151], v3 offset:1024
    s_mov_b32 s48, s58
    s_lshl_b32 s48, s48, 5
    s_add_u32 s48, s48, s47
    s_lshl_b32 s50, s48, 10
    s_add_u32 s50, s50, 0xe80000
    s_add_u32 s51, s50, 0x8000
    s_lshl_b32 s52, s48, 7
    s_add_u32 s52, s52, 0x1080000
    s_add_u32 s53, s52, 0x1000
    v_mov_b32 v160, -1
    v_mov_b32 v161, -1
    v_mov_b32 v162, -1
    v_mov_b32 v163, -1
    s_add_u32 s48, s50, 0x240000
    buffer_store_dwordx4 v[160:163], v244, s[40:43], s48 offen sc1
    s_add_u32 s48, s51, 0x240000
    buffer_store_dwordx4 v[160:163], v244, s[40:43], s48 offen sc1
    s_mov_b32 exec_hi, 0
    s_add_u32 s48, s52, 0x240000
    buffer_store_dword v160, v245, s[40:43], s48 offen sc1
    s_add_u32 s48, s53, 0x240000
    buffer_store_dword v160, v245, s[40:43], s48 offen sc1
    s_mov_b32 exec_hi, -1
    s_waitcnt lgkmcnt(0)
    s_setprio 0
    v_mfma_f32_32x32x8_bf16 v[80:95], v[152:153], v[212:213], 0
    v_mfma_f32_32x32x8_bf16 v[96:111], v[152:153], v[222:223], 0
    s_nop 8
    v_mfma_f32_32x32x16_bf16 v[80:95], v[144:147], v[204:207], v[80:95]
    v_mfma_f32_32x32x16_bf16 v[96:111], v[144:147], v[214:217], v[96:111]
    v_mfma_f32_32x32x16_bf16 v[80:95], v[148:151], v[208:211], v[80:95]
    v_mfma_f32_32x32x16_bf16 v[96:111], v[148:151], v[218:221], v[96:111]
    s_nop 10
    s_setprio 1
    v_add_f32 v90, 0x358637bd, v90
    v_add_f32 v106, 0x358637bd, v106
    v_rcp_f32 v90, v90
    v_rcp_f32 v106, v106
    s_nop 0
    v_pk_mul_f32 v[80:81], v[80:81], v[90:91] op_sel_hi:[1,0]
    v_pk_mul_f32 v[82:83], v[82:83], v[90:91] op_sel_hi:[1,0]
    v_pk_mul_f32 v[84:85], v[84:85], v[90:91] op_sel_hi:[1,0]
    v_pk_mul_f32 v[86:87], v[86:87], v[90:91] op_sel_hi:[1,0]
    v_pk_mul_f32 v[88:89], v[88:89], v[90:91] op_sel_hi:[1,0]
    v_cvt_pk_bf16_f32 v112, v80, v81
    v_cvt_pk_bf16_f32 v113, v82, v83
    v_cvt_pk_bf16_f32 v114, v84, v85
    v_cvt_pk_bf16_f32 v115, v86, v87
    buffer_store_dwordx4 v[112:115], v244, s[40:43], s50 offen sc1
    v_cvt_pk_bf16_f32 v116, v88, v89
    v_pk_mul_f32 v[96:97], v[96:97], v[106:107] op_sel_hi:[1,0]
    v_pk_mul_f32 v[98:99], v[98:99], v[106:107] op_sel_hi:[1,0]
    v_pk_mul_f32 v[100:101], v[100:101], v[106:107] op_sel_hi:[1,0]
    v_pk_mul_f32 v[102:103], v[102:103], v[106:107] op_sel_hi:[1,0]
    v_pk_mul_f32 v[104:105], v[104:105], v[106:107] op_sel_hi:[1,0]
    v_cvt_pk_bf16_f32 v120, v96, v97
    v_cvt_pk_bf16_f32 v121, v98, v99
    v_cvt_pk_bf16_f32 v122, v100, v101
    v_cvt_pk_bf16_f32 v123, v102, v103
    buffer_store_dwordx4 v[120:123], v244, s[40:43], s51 offen sc1
    v_cvt_pk_bf16_f32 v124, v104, v105
    s_mov_b32 exec_hi, 0
    buffer_store_dword v116, v245, s[40:43], s52 offen sc1
    buffer_store_dword v124, v245, s[40:43], s53 offen sc1
    s_mov_b32 exec_hi, -1
    s_lshr_b32 s54, s58, 1
    s_lshl_b32 s49, s54, 5
    s_add_u32 s49, s49, s47
    s_lshl_b32 s49, s49, 7
    s_add_u32 s49, s49, 0x1440000
    v_mov_b32 v2, s49
    v_mov_b32 v3, s73
    s_waitcnt vmcnt(0)
    s_mov_b64 exec, 1
    buffer_store_dword v3, v2, s[40:43], 0 offen sc1
    s_mov_b64 exec, -1
    s_or_b32 s54, s75, s69
    ds_read_b64_tr_b16 v[16:17], v236 offset:0
    ds_read_b64_tr_b16 v[18:19], v236 offset:1024
    ds_read_b64_tr_b16 v[20:21], v237 offset:0
    ds_read_b64_tr_b16 v[22:23], v237 offset:1024
    ds_read_b64_tr_b16 v[24:25], v236 offset:2560
    ds_read_b64_tr_b16 v[26:27], v236 offset:3584
    ds_read_b64_tr_b16 v[28:29], v237 offset:2560
    ds_read_b64_tr_b16 v[30:31], v237 offset:3584
    ds_read_b64_tr_b16 v[32:33], v236 offset:4608
    ds_read_b64_tr_b16 v[34:35], v236 offset:5632
    ds_read_b64_tr_b16 v[36:37], v237 offset:4608
    ds_read_b64_tr_b16 v[38:39], v237 offset:5632
    ds_read_b64_tr_b16 v[40:41], v236 offset:7168
    ds_read_b64_tr_b16 v[42:43], v236 offset:8192
    ds_read_b64_tr_b16 v[44:45], v237 offset:7168
    ds_read_b64_tr_b16 v[46:47], v237 offset:8192
    ds_read_b64_tr_b16 v[48:49], v236 offset:9216
    ds_read_b64_tr_b16 v[50:51], v236 offset:10240
    ds_read_b64_tr_b16 v[52:53], v237 offset:9216
    ds_read_b64_tr_b16 v[54:55], v237 offset:10240
    ds_read_b64_tr_b16 v[56:57], v236 offset:11776
    ds_read_b64_tr_b16 v[58:59], v236 offset:12800
    ds_read_b64_tr_b16 v[60:61], v237 offset:11776
    ds_read_b64_tr_b16 v[62:63], v237 offset:12800
    ds_read_b64_tr_b16 v[64:65], v236 offset:13824
    ds_read_b64_tr_b16 v[66:67], v236 offset:14848
    ds_read_b64_tr_b16 v[68:69], v237 offset:13824
    ds_read_b64_tr_b16 v[70:71], v237 offset:14848
    ds_read_b64_tr_b16 v[72:73], v236 offset:16384
    ds_read_b64_tr_b16 v[74:75], v236 offset:17408
    ds_read_b64_tr_b16 v[76:77], v237 offset:16384
    ds_read_b64_tr_b16 v[78:79], v237 offset:17408
    ds_read_b64_tr_b16 v[80:81], v238 offset:0
    ds_read_b64_tr_b16 v[82:83], v238 offset:4608
    ds_read_b64_tr_b16 v[84:85], v239 offset:0
    ds_read_b64_tr_b16 v[86:87], v239 offset:4608
    s_cmp_eq_u32 s54, 0
    s_cbranch_scc1 L_ne68
    ds_read_b64_tr_b16 v[88:89], v240 offset:0
    ds_read_b64_tr_b16 v[90:91], v240 offset:512
    ds_read_b64_tr_b16 v[92:93], v240 offset:1280
    ds_read_b64_tr_b16 v[94:95], v240 offset:1792
    ds_read_b64_tr_b16 v[96:97], v240 offset:2304
    ds_read_b64_tr_b16 v[98:99], v240 offset:2816
    ds_read_b64_tr_b16 v[100:101], v240 offset:3584
    ds_read_b64_tr_b16 v[102:103], v240 offset:4096
    ds_read_b64_tr_b16 v[104:105], v240 offset:4608
    ds_read_b64_tr_b16 v[106:107], v240 offset:5120
    ds_read_b64_tr_b16 v[108:109], v240 offset:5888
    ds_read_b64_tr_b16 v[110:111], v240 offset:6400
    ds_read_b64_tr_b16 v[112:113], v240 offset:6912
    ds_read_b64_tr_b16 v[114:115], v240 offset:7424
    ds_read_b64_tr_b16 v[116:117], v240 offset:8192
    ds_read_b64_tr_b16 v[118:119], v240 offset:8704
    ds_read_b64_tr_b16 v[120:121], v241 offset:0
    ds_read_b64_tr_b16 v[122:123], v241 offset:2304
L_ne68:
    s_lshl_b32 s49, s71, 1
    s_add_u32 s53, s77, s49
    s_lshl_b32 s48, s53, 5
    s_lshl_b32 s49, s78, 4
    s_add_u32 s55, s48, s49
    s_lshl_b32 s59, s55, 10
    s_add_u32 s59, s59, 0xe80000
    s_add_u32 s60, s59, 4096
    s_lshl_b32 s61, s55, 7
    s_add_u32 s61, s61, 0x1080000
    s_waitcnt lgkmcnt(0)
    s_mov_b64 exec, 1
    ds_add_u32 v246, v247 offset:36
    s_mov_b64 exec, -1
L_lw69:
    ds_read_b32 v2, v246 offset:36
    s_waitcnt lgkmcnt(0)
    v_readfirstlane_b32 s48, v2
    s_cmp_ge_u32 s48, 4
    s_cbranch_scc1 L_lwd70
    s_sleep 2
    s_sub_u32 s76, s76, 1
    s_cbranch_scc0 L_lw69
    s_endpgm
L_lwd70:
    s_add_u32 s70, s99, 165888
    s_lshl_b32 s3, s96, 10
    s_add_u32 m0, s3, 102400
    s_nop 0
    buffer_load_dwordx4 v224, s[28:31], s70 offen lds
    s_add_u32 m0, s3, 106496
    s_add_u32 s70, s70, 36864
    buffer_load_dwordx4 v224, s[28:31], s70 offen lds
    s_cmp_lg_u32 s96, 2
    s_cbranch_scc1 L_r871
    s_mov_b32 m0, 110592
    s_add_u32 s70, s70, 18432
    buffer_load_dwordx4 v224, s[28:31], s70 offen lds
L_r871:
    s_add_u32 s70, s99, 248832
    s_lshl_b32 s3, s96, 10
    s_add_u32 m0, s3, 111616
    s_nop 0
    buffer_load_dwordx4 v224, s[28:31], s70 offen lds
    s_add_u32 m0, s3, 115712
    s_add_u32 s70, s70, 36864
    buffer_load_dwordx4 v224, s[28:31], s70 offen lds
    s_cmp_lg_u32 s96, 3
    s_cbranch_scc1 L_r872
    s_mov_b32 m0, 119808
    s_add_u32 s70, s70, 9216
    buffer_load_dwordx4 v224, s[28:31], s70 offen lds
L_r872:
    v_mov_b32 v4, v236
    v_subrev_u32 v10, 73728, v236
    v_mov_b32 v5, v237
    v_subrev_u32 v11, 73728, v237
    v_mov_b32 v6, v238
    v_subrev_u32 v12, 73728, v238
    v_mov_b32 v7, v239
    v_subrev_u32 v13, 73728, v239
    v_subrev_u32 v14, 73728, v240
    v_subrev_u32 v15, 73728, v241
    s_mov_b32 s56, 0
    s_mov_b32 s57, 0
    s_mov_b32 s63, 0
    s_add_u32 s70, s99, 331776
    s_lshl_b32 s3, s96, 10
    s_add_u32 m0, s3, 120832
    s_nop 0
    buffer_load_dwordx4 v224, s[28:31], s70 offen lds
    s_add_u32 m0, s3, 124928
    s_add_u32 s70, s70, 36864
    buffer_load_dwordx4 v224, s[28:31], s70 offen lds
    s_cmp_lg_u32 s96, 0
    s_cbranch_scc1 L_r873
    s_mov_b32 m0, 129024
    s_add_u32 s70, s70, 36864
    buffer_load_dwordx4 v224, s[28:31], s70 offen lds
L_r873:
    s_add_u32 s70, s99, 414720
    s_lshl_b32 s3, s96, 10
    s_add_u32 m0, s3, 130048
    s_nop 0
    buffer_load_dwordx4 v224, s[28:31], s70 offen lds
    s_add_u32 m0, s3, 134144
    s_add_u32 s70, s70, 36864
    buffer_load_dwordx4 v224, s[28:31], s70 offen lds
    s_cmp_lg_u32 s96, 1
    s_cbranch_scc1 L_r874
    s_mov_b32 m0, 138240
    s_add_u32 s70, s70, 27648
    buffer_load_dwordx4 v224, s[28:31], s70 offen lds
L_r874:
L_poll75:
    buffer_load_dword v2, v242, s[40:43], 0 offen sc1
    s_waitcnt vmcnt(0)
L_pollc77:
    v_cmp_ne_u32 vcc, s73, v2
    s_cbranch_vccz L_polld76
    s_sleep 2
    s_sub_u32 s76, s76, 1
    s_cbranch_scc0 L_poll75
    s_endpgm
L_polld76:
    buffer_load_dwordx4 v[124:127], v244, s[40:43], s59 offen offset:0 sc1
    buffer_load_dwordx4 v[128:131], v244, s[40:43], s59 offen offset:1024 sc1
    buffer_load_dwordx4 v[132:135], v244, s[40:43], s59 offen offset:2048 sc1
    buffer_load_dwordx4 v[136:139], v244, s[40:43], s59 offen offset:3072 sc1
    s_waitcnt vmcnt(2)
    buffer_load_dwordx4 v[140:143], v244, s[40:43], s60 offen offset:0 sc1
    buffer_load_dwordx4 v[144:147], v244, s[40:43], s60 offen offset:1024 sc1
    buffer_load_dwordx4 v[148:151], v244, s[40:43], s60 offen offset:2048 sc1
    buffer_load_dwordx4 v[152:155], v244, s[40:43], s60 offen offset:3072 sc1
    buffer_load_dword v156, v251, s[40:43], s61 offen offset:0 sc1
    buffer_load_dword v157, v251, s[40:43], s61 offen offset:128 sc1
    buffer_load_dword v158, v251, s[40:43], s61 offen offset:256 sc1
    buffer_load_dword v159, v251, s[40:43], s61 offen offset:384 sc1
    s_add_u32 s70, s99, 497664
    s_lshl_b32 s3, s96, 10
    s_add_u32 m0, s3, 139264
    s_nop 0
    buffer_load_dwordx4 v224, s[28:31], s70 offen lds
    s_add_u32 m0, s3, 143360
    s_add_u32 s70, s70, 36864
    buffer_load_dwordx4 v224, s[28:31], s70 offen lds
    s_cmp_lg_u32 s96, 2
    s_cbranch_scc1 L_r878
    s_mov_b32 m0, 147456
    s_add_u32 s70, s70, 18432
    buffer_load_dwordx4 v224, s[28:31], s70 offen lds
L_r878:
    s_waitcnt vmcnt(2)
    s_add_u32 s59, s59, 8192
    s_add_u32 s60, s60, 8192
    s_add_u32 s61, s61, 1024
    buffer_load_dwordx4 v[160:163], v244, s[40:43], s59 offen offset:0 sc1
    buffer_load_dwordx4 v[164:167], v244, s[40:43], s59 offen offset:1024 sc1
    buffer_load_dwordx4 v[168:171], v244, s[40:43], s59 offen offset:2048 sc1
    buffer_load_dwordx4 v[172:175], v244, s[40:43], s59 offen offset:3072 sc1
    s_waitcnt vmcnt(2)
    buffer_load_dwordx4 v[176:179], v244, s[40:43], s60 offen offset:0 sc1
    buffer_load_dwordx4 v[180:183], v244, s[40:43], s60 offen offset:1024 sc1
    buffer_load_dwordx4 v[184:187], v244, s[40:43], s60 offen offset:2048 sc1
    buffer_load_dwordx4 v[188:191], v244, s[40:43], s60 offen offset:3072 sc1
    buffer_load_dword v192, v251, s[40:43], s61 offen offset:0 sc1
    buffer_load_dword v193, v251, s[40:43], s61 offen offset:128 sc1
    buffer_load_dword v194, v251, s[40:43], s61 offen offset:256 sc1
    buffer_load_dword v195, v251, s[40:43], s61 offen offset:384 sc1
    s_add_u32 s70, s99, 580608
    s_lshl_b32 s3, s96, 10
    s_add_u32 m0, s3, 148480
    s_nop 0
    buffer_load_dwordx4 v224, s[28:31], s70 offen lds
    s_add_u32 m0, s3, 152576
    s_add_u32 s70, s70, 36864
    buffer_load_dwordx4 v224, s[28:31], s70 offen lds
    s_cmp_lg_u32 s96, 3
    s_cbranch_scc1 L_r879
    s_mov_b32 m0, 156672
    s_add_u32 s70, s70, 9216
    buffer_load_dwordx4 v224, s[28:31], s70 offen lds
L_r879:
    s_waitcnt vmcnt(2)
    s_waitcnt vmcnt(0)
    s_setprio 0
    s_barrier
    s_setprio 1
    v_mfma_f32_32x32x16_bf16 v[212:227], v[16:19], v[124:127], 0
    v_mfma_f32_32x32x16_bf16 v[228:243], v[20:23], v[124:127], 0
    v_mfma_f32_32x32x16_bf16 v[212:227], v[24:27], v[128:131], v[212:227]
    ds_read_b64_tr_b16 v[16:17], v10 offset:0
    ds_read_b64_tr_b16 v[18:19], v10 offset:1024
    v_mfma_f32_32x32x16_bf16 v[228:243], v[28:31], v[128:131], v[228:243]
    ds_read_b64_tr_b16 v[20:21], v11 offset:0
    ds_read_b64_tr_b16 v[22:23], v11 offset:1024
    v_mfma_f32_32x32x16_bf16 v[212:227], v[32:35], v[132:135], v[212:227]
    ds_read_b64_tr_b16 v[24:25], v10 offset:2560
    ds_read_b64_tr_b16 v[26:27], v10 offset:3584
    v_mfma_f32_32x32x16_bf16 v[228:243], v[36:39], v[132:135], v[228:243]
    ds_read_b64_tr_b16 v[28:29], v11 offset:2560
    ds_read_b64_tr_b16 v[30:31], v11 offset:3584
    v_mfma_f32_32x32x16_bf16 v[212:227], v[40:43], v[136:139], v[212:227]
    ds_read_b64_tr_b16 v[32:33], v10 offset:4608
    ds_read_b64_tr_b16 v[34:35], v10 offset:5632
    v_mfma_f32_32x32x16_bf16 v[228:243], v[44:47], v[136:139], v[228:243]
    ds_read_b64_tr_b16 v[36:37], v11 offset:4608
    ds_read_b64_tr_b16 v[38:39], v11 offset:5632
    v_mfma_f32_32x32x16_bf16 v[212:227], v[48:51], v[140:143], v[212:227]
    ds_read_b64_tr_b16 v[40:41], v10 offset:7168
    ds_read_b64_tr_b16 v[42:43], v10 offset:8192
    v_mfma_f32_32x32x16_bf16 v[228:243], v[52:55], v[140:143], v[228:243]
    ds_read_b64_tr_b16 v[44:45], v11 offset:7168
    ds_read_b64_tr_b16 v[46:47], v11 offset:8192
    v_mfma_f32_32x32x16_bf16 v[212:227], v[56:59], v[144:147], v[212:227]
    ds_read_b64_tr_b16 v[48:49], v10 offset:9216
    ds_read_b64_tr_b16 v[50:51], v10 offset:10240
    v_mfma_f32_32x32x16_bf16 v[228:243], v[60:63], v[144:147], v[228:243]
    ds_read_b64_tr_b16 v[52:53], v11 offset:9216
    ds_read_b64_tr_b16 v[54:55], v11 offset:10240
    v_mfma_f32_32x32x16_bf16 v[212:227], v[64:67], v[148:151], v[212:227]
    ds_read_b64_tr_b16 v[56:57], v10 offset:11776
    ds_read_b64_tr_b16 v[58:59], v10 offset:12800
    v_mfma_f32_32x32x16_bf16 v[228:243], v[68:71], v[148:151], v[228:243]
    ds_read_b64_tr_b16 v[60:61], v11 offset:11776
    ds_read_b64_tr_b16 v[62:63], v11 offset:12800
    v_mfma_f32_32x32x16_bf16 v[212:227], v[72:75], v[152:155], v[212:227]
    ds_read_b64_tr_b16 v[64:65], v10 offset:13824
    ds_read_b64_tr_b16 v[66:67], v10 offset:14848
    v_mfma_f32_32x32x16_bf16 v[228:243], v[76:79], v[152:155], v[228:243]
    ds_read_b64_tr_b16 v[68:69], v11 offset:13824
    ds_read_b64_tr_b16 v[70:71], v11 offset:14848
    v_mfma_f32_32x32x16_bf16 v[212:227], v[80:83], v[156:159], v[212:227]
    ds_read_b64_tr_b16 v[72:73], v10 offset:16384
    ds_read_b64_tr_b16 v[74:75], v10 offset:17408
    v_mfma_f32_32x32x16_bf16 v[228:243], v[84:87], v[156:159], v[228:243]
    ds_read_b64_tr_b16 v[76:77], v11 offset:16384
    ds_read_b64_tr_b16 v[78:79], v11 offset:17408
    ds_read_b64_tr_b16 v[80:81], v12 offset:0
    ds_read_b64_tr_b16 v[82:83], v12 offset:4608
    ds_read_b64_tr_b16 v[84:85], v13 offset:0
    ds_read_b64_tr_b16 v[86:87], v13 offset:4608
    s_cmp_eq_u32 s75, 0
    s_cbranch_scc1 L_xa80
    v_mfma_f32_32x32x16_bf16 v[196:211], v[88:91], v[124:127], 0
    v_mfma_f32_32x32x16_bf16 v[196:211], v[92:95], v[128:131], v[196:211]
    ds_read_b64_tr_b16 v[88:89], v14 offset:0
    ds_read_b64_tr_b16 v[90:91], v14 offset:512
    v_mfma_f32_32x32x16_bf16 v[196:211], v[96:99], v[132:135], v[196:211]
    ds_read_b64_tr_b16 v[92:93], v14 offset:1280
    ds_read_b64_tr_b16 v[94:95], v14 offset:1792
    v_mfma_f32_32x32x16_bf16 v[196:211], v[100:103], v[136:139], v[196:211]
    ds_read_b64_tr_b16 v[96:97], v14 offset:2304
    ds_read_b64_tr_b16 v[98:99], v14 offset:2816
    v_mfma_f32_32x32x16_bf16 v[196:211], v[104:107], v[140:143], v[196:211]
    ds_read_b64_tr_b16 v[100:101], v14 offset:3584
    ds_read_b64_tr_b16 v[102:103], v14 offset:4096
    v_mfma_f32_32x32x16_bf16 v[196:211], v[108:111], v[144:147], v[196:211]
    ds_read_b64_tr_b16 v[104:105], v14 offset:4608
    ds_read_b64_tr_b16 v[106:107], v14 offset:5120
    v_mfma_f32_32x32x16_bf16 v[196:211], v[112:115], v[148:151], v[196:211]
    ds_read_b64_tr_b16 v[108:109], v14 offset:5888
    ds_read_b64_tr_b16 v[110:111], v14 offset:6400
    v_mfma_f32_32x32x16_bf16 v[196:211], v[116:119], v[152:155], v[196:211]
    ds_read_b64_tr_b16 v[112:113], v14 offset:6912
    ds_read_b64_tr_b16 v[114:115], v14 offset:7424
    v_mfma_f32_32x32x16_bf16 v[196:211], v[120:123], v[156:159], v[196:211]
    ds_read_b64_tr_b16 v[116:117], v14 offset:8192
    ds_read_b64_tr_b16 v[118:119], v14 offset:8704
    ds_read_b64_tr_b16 v[120:121], v15 offset:0
    ds_read_b64_tr_b16 v[122:123], v15 offset:2304
L_xa80:
    s_waitcnt lgkmcnt(0)
    s_mov_b64 exec, 1
    ds_add_u32 v246, v247 offset:48
    s_mov_b64 exec, -1
    v_mfma_f32_32x32x16_bf16 v[212:227], v[16:19], v[160:163], v[212:227]
    v_mfma_f32_32x32x16_bf16 v[228:243], v[20:23], v[160:163], v[228:243]
    v_mfma_f32_32x32x16_bf16 v[212:227], v[24:27], v[164:167], v[212:227]
    ds_read_b64_tr_b16 v[16:17], v4 offset:18432
    ds_read_b64_tr_b16 v[18:19], v4 offset:19456
    v_mfma_f32_32x32x16_bf16 v[228:243], v[28:31], v[164:167], v[228:243]
    ds_read_b64_tr_b16 v[20:21], v5 offset:18432
    ds_read_b64_tr_b16 v[22:23], v5 offset:19456
    v_mfma_f32_32x32x16_bf16 v[212:227], v[32:35], v[168:171], v[212:227]
    ds_read_b64_tr_b16 v[24:25], v4 offset:20992
    ds_read_b64_tr_b16 v[26:27], v4 offset:22016
    v_mfma_f32_32x32x16_bf16 v[228:243], v[36:39], v[168:171], v[228:243]
    ds_read_b64_tr_b16 v[28:29], v5 offset:20992
    ds_read_b64_tr_b16 v[30:31], v5 offset:22016
    v_mfma_f32_32x32x16_bf16 v[212:227], v[40:43], v[172:175], v[212:227]
    ds_read_b64_tr_b16 v[32:33], v4 offset:23040
    ds_read_b64_tr_b16 v[34:35], v4 offset:24064
    v_mfma_f32_32x32x16_bf16 v[228:243], v[44:47], v[172:175], v[228:243]
    ds_read_b64_tr_b16 v[36:37], v5 offset:23040
    ds_read_b64_tr_b16 v[38:39], v5 offset:24064
    v_mfma_f32_32x32x16_bf16 v[212:227], v[48:51], v[176:179], v[212:227]
    ds_read_b64_tr_b16 v[40:41], v4 offset:25600
    ds_read_b64_tr_b16 v[42:43], v4 offset:26624
    v_mfma_f32_32x32x16_bf16 v[228:243], v[52:55], v[176:179], v[228:243]
    ds_read_b64_tr_b16 v[44:45], v5 offset:25600
    ds_read_b64_tr_b16 v[46:47], v5 offset:26624
    v_mfma_f32_32x32x16_bf16 v[212:227], v[56:59], v[180:183], v[212:227]
    ds_read_b64_tr_b16 v[48:49], v4 offset:27648
    ds_read_b64_tr_b16 v[50:51], v4 offset:28672
    v_mfma_f32_32x32x16_bf16 v[228:243], v[60:63], v[180:183], v[228:243]
    ds_read_b64_tr_b16 v[52:53], v5 offset:27648
    ds_read_b64_tr_b16 v[54:55], v5 offset:28672
    buffer_load_dword v250, v254, s[40:43], 0 offen sc1
    v_mfma_f32_32x32x16_bf16 v[212:227], v[64:67], v[184:187], v[212:227]
    ds_read_b64_tr_b16 v[56:57], v4 offset:30208
    ds_read_b64_tr_b16 v[58:59], v4 offset:31232
    v_mfma_f32_32x32x16_bf16 v[228:243], v[68:71], v[184:187], v[228:243]
    ds_read_b64_tr_b16 v[60:61], v5 offset:30208
    ds_read_b64_tr_b16 v[62:63], v5 offset:31232
    v_mfma_f32_32x32x16_bf16 v[212:227], v[72:75], v[188:191], v[212:227]
    ds_read_b64_tr_b16 v[64:65], v4 offset:32256
    ds_read_b64_tr_b16 v[66:67], v4 offset:33280
    v_mfma_f32_32x32x16_bf16 v[228:243], v[76:79], v[188:191], v[228:243]
    ds_read_b64_tr_b16 v[68:69], v5 offset:32256
    ds_read_b64_tr_b16 v[70:71], v5 offset:33280
    v_mfma_f32_32x32x16_bf16 v[212:227], v[80:83], v[192:195], v[212:227]
    ds_read_b64_tr_b16 v[72:73], v4 offset:34816
    ds_read_b64_tr_b16 v[74:75], v4 offset:35840
    v_mfma_f32_32x32x16_bf16 v[228:243], v[84:87], v[192:195], v[228:243]
    ds_read_b64_tr_b16 v[76:77], v5 offset:34816
    ds_read_b64_tr_b16 v[78:79], v5 offset:35840
    ds_read_b64_tr_b16 v[80:81], v6 offset:18432
    ds_read_b64_tr_b16 v[82:83], v6 offset:23040
    ds_read_b64_tr_b16 v[84:85], v7 offset:18432
    ds_read_b64_tr_b16 v[86:87], v7 offset:23040
    s_cmp_eq_u32 s75, 0
    s_cbranch_scc1 L_xa81
    v_mfma_f32_32x32x16_bf16 v[196:211], v[88:91], v[160:163], v[196:211]
    v_mfma_f32_32x32x16_bf16 v[196:211], v[92:95], v[164:167], v[196:211]
    v_mfma_f32_32x32x16_bf16 v[196:211], v[96:99], v[168:171], v[196:211]
    v_mfma_f32_32x32x16_bf16 v[196:211], v[100:103], v[172:175], v[196:211]
    v_mfma_f32_32x32x16_bf16 v[196:211], v[104:107], v[176:179], v[196:211]
    v_mfma_f32_32x32x16_bf16 v[196:211], v[108:111], v[180:183], v[196:211]
    v_mfma_f32_32x32x16_bf16 v[196:211], v[112:115], v[184:187], v[196:211]
    v_mfma_f32_32x32x16_bf16 v[196:211], v[116:119], v[188:191], v[196:211]
    v_mfma_f32_32x32x16_bf16 v[196:211], v[120:123], v[192:195], v[196:211]
L_xa81:
    s_setprio 0
L_lw82:
    ds_read_b32 v2, v246 offset:48
    s_waitcnt lgkmcnt(0)
    v_readfirstlane_b32 s48, v2
    s_cmp_ge_u32 s48, 4
    s_cbranch_scc1 L_lwd83
    s_sub_u32 s76, s76, 1
    s_cbranch_scc0 L_lw82
    s_endpgm
L_lwd83:
    s_mov_b64 exec, 1
    ds_add_u32 v246, v247 offset:52
    s_mov_b64 exec, -1
    s_mul_i32 s48, s96, 8704
    s_add_u32 s48, s48, 28672
    v_add_u32 v1, s48, v244
    ds_write_b128 v1, v[212:215] offset:0
    ds_write_b128 v1, v[216:219] offset:1088
    ds_write_b128 v1, v[220:223] offset:2176
    ds_write_b128 v1, v[224:227] offset:3264
    ds_write_b128 v1, v[228:231] offset:4352
    ds_write_b128 v1, v[232:235] offset:5440
    ds_write_b128 v1, v[236:239] offset:6528
    ds_write_b128 v1, v[240:243] offset:7616
    s_cmp_eq_u32 s75, 0
    s_cbranch_scc1 L_anx
    s_mul_i32 s48, s78, 4352
    s_add_u32 s48, s48, 65536
    v_add_u32 v1, s48, v244
    ds_write_b128 v1, v[196:199] offset:0
    ds_write_b128 v1, v[200:203] offset:1088
    ds_write_b128 v1, v[204:207] offset:2176
    ds_write_b128 v1, v[208:211] offset:3264
L_anx:
L_final:
L_fpoll:
    s_waitcnt vmcnt(0) lgkmcnt(0)
    s_cmp_lg_u32 s56, 1
    s_cbranch_scc1 L_fv84
    v_max3_u32 v2, v124, v125, v126
    v_max3_u32 v3, v127, v128, v129
    v_max3_u32 v2, v2, v130, v131
    v_max3_u32 v3, v3, v132, v133
    v_max3_u32 v2, v2, v134, v135
    v_max3_u32 v3, v3, v136, v137
    v_max3_u32 v2, v2, v138, v139
    v_max_u32 v2, v2, v3
    v_cmp_eq_u32 s[60:61], -1, v2
    s_cmp_lg_u64 s[60:61], 0
    s_cselect_b32 s56, 0, 2
L_fv84:
    s_cmp_lg_u32 s57, 1
    s_cbranch_scc1 L_fv85
    v_max3_u32 v2, v140, v141, v142
    v_max3_u32 v3, v143, v144, v145
    v_max3_u32 v2, v2, v146, v147
    v_max3_u32 v3, v3, v148, v149
    v_max3_u32 v2, v2, v150, v151
    v_max3_u32 v3, v3, v152, v153
    v_max3_u32 v2, v2, v154, v155
    v_max_u32 v2, v2, v3
    v_cmp_eq_u32 s[60:61], -1, v2
    s_cmp_lg_u64 s[60:61], 0
    s_cselect_b32 s57, 0, 2
L_fv85:
    s_cmp_lg_u32 s63, 1
    s_cbranch_scc1 L_fv86
    v_max3_u32 v2, v156, v157, v158
    v_max_u32 v2, v2, v159
    v_cmp_eq_u32 s[60:61], -1, v2
    s_cmp_lg_u64 s[60:61], 0
    s_cselect_b32 s63, 0, 2
L_fv86:
    s_min_u32 s48, s56, s57
    s_min_u32 s48, s48, s63
    s_cmp_ge_u32 s48, 2
    s_cbranch_scc1 L_fgo
    v_cmp_ne_u32 vcc, s73, v250
    s_and_b32 s48, vcc_lo, 15
    s_or_b32 s48, s48, s56
    s_cbranch_scc1 L_fl87
    s_mov_b32 s56, 1
L_fg88:
    buffer_load_dwordx4 v[124:127], v244, s[40:43], s64 offen offset:0 sc1
    buffer_load_dwordx4 v[128:131], v244, s[40:43], s64 offen offset:1024 sc1
    buffer_load_dwordx4 v[132:135], v244, s[40:43], s64 offen offset:2048 sc1
    buffer_load_dwordx4 v[136:139], v244, s[40:43], s64 offen offset:3072 sc1
L_fl87:
    s_and_b32 s48, vcc_lo, 240
    s_or_b32 s48, s48, s57
    s_cbranch_scc1 L_fl89
    s_mov_b32 s57, 1
L_fg90:
    buffer_load_dwordx4 v[140:143], v244, s[40:43], s65 offen offset:0 sc1
    buffer_load_dwordx4 v[144:147], v244, s[40:43], s65 offen offset:1024 sc1
    buffer_load_dwordx4 v[148:151], v244, s[40:43], s65 offen offset:2048 sc1
    buffer_load_dwordx4 v[152:155], v244, s[40:43], s65 offen offset:3072 sc1
L_fl89:
    s_min_u32 s48, s56, s57
    s_cmp_eq_u32 s48, 0
    s_cbranch_scc1 L_fc91
    s_cmp_eq_u32 s63, 2
    s_cbranch_scc1 L_fd92
    s_mov_b32 s63, 1
    buffer_load_dword v156, v251, s[40:43], s67 offen offset:0 sc1
    buffer_load_dword v157, v251, s[40:43], s67 offen offset:128 sc1
    buffer_load_dword v158, v251, s[40:43], s67 offen offset:256 sc1
    buffer_load_dword v159, v251, s[40:43], s67 offen offset:384 sc1
    s_branch L_fd92
L_fc91:
    buffer_load_dword v250, v254, s[40:43], 0 offen sc1
L_fd92:
    s_cmp_lg_u32 s56, 2
    s_cbranch_scc1 L_fm93
    s_mov_b32 s56, 3
    v_mfma_f32_32x32x16_bf16 v[160:175], v[16:19], v[124:127], 0
    v_mfma_f32_32x32x16_bf16 v[176:191], v[20:23], v[124:127], 0
    v_mfma_f32_32x32x16_bf16 v[160:175], v[24:27], v[128:131], v[160:175]
    v_mfma_f32_32x32x16_bf16 v[176:191], v[28:31], v[128:131], v[176:191]
    v_mfma_f32_32x32x16_bf16 v[160:175], v[32:35], v[132:135], v[160:175]
    v_mfma_f32_32x32x16_bf16 v[176:191], v[36:39], v[132:135], v[176:191]
    v_mfma_f32_32x32x16_bf16 v[160:175], v[40:43], v[136:139], v[160:175]
    v_mfma_f32_32x32x16_bf16 v[176:191], v[44:47], v[136:139], v[176:191]
    s_cmp_eq_u32 s69, 0
    s_cbranch_scc1 L_nx94
    v_mfma_f32_32x32x16_bf16 v[192:207], v[88:91], v[124:127], 0
    v_mfma_f32_32x32x16_bf16 v[192:207], v[92:95], v[128:131], v[192:207]
    v_mfma_f32_32x32x16_bf16 v[192:207], v[96:99], v[132:135], v[192:207]
    v_mfma_f32_32x32x16_bf16 v[192:207], v[100:103], v[136:139], v[192:207]
L_nx94:
L_fm93:
    s_sub_u32 s76, s76, 1
    s_cbranch_scc0 L_fpoll
    s_endpgm
L_fgo:
    s_cmp_lg_u32 s56, 2
    s_cbranch_scc1 L_fm95
    s_mov_b32 s56, 3
    v_mfma_f32_32x32x16_bf16 v[160:175], v[16:19], v[124:127], 0
    v_mfma_f32_32x32x16_bf16 v[176:191], v[20:23], v[124:127], 0
    v_mfma_f32_32x32x16_bf16 v[160:175], v[24:27], v[128:131], v[160:175]
    v_mfma_f32_32x32x16_bf16 v[176:191], v[28:31], v[128:131], v[176:191]
    v_mfma_f32_32x32x16_bf16 v[160:175], v[32:35], v[132:135], v[160:175]
    v_mfma_f32_32x32x16_bf16 v[176:191], v[36:39], v[132:135], v[176:191]
    v_mfma_f32_32x32x16_bf16 v[160:175], v[40:43], v[136:139], v[160:175]
    v_mfma_f32_32x32x16_bf16 v[176:191], v[44:47], v[136:139], v[176:191]
    s_cmp_eq_u32 s69, 0
    s_cbranch_scc1 L_nx96
    v_mfma_f32_32x32x16_bf16 v[192:207], v[88:91], v[124:127], 0
    v_mfma_f32_32x32x16_bf16 v[192:207], v[92:95], v[128:131], v[192:207]
    v_mfma_f32_32x32x16_bf16 v[192:207], v[96:99], v[132:135], v[192:207]
    v_mfma_f32_32x32x16_bf16 v[192:207], v[100:103], v[136:139], v[192:207]
L_nx96:
L_fm95:
    ds_read_b32 v6, v246 offset:52
    v_mfma_f32_32x32x16_bf16 v[160:175], v[48:51], v[140:143], v[160:175]
    v_mfma_f32_32x32x16_bf16 v[176:191], v[52:55], v[140:143], v[176:191]
    v_mfma_f32_32x32x16_bf16 v[160:175], v[56:59], v[144:147], v[160:175]
    v_mfma_f32_32x32x16_bf16 v[176:191], v[60:63], v[144:147], v[176:191]
    v_mfma_f32_32x32x16_bf16 v[160:175], v[64:67], v[148:151], v[160:175]
    v_mfma_f32_32x32x16_bf16 v[176:191], v[68:71], v[148:151], v[176:191]
    v_mfma_f32_32x32x16_bf16 v[160:175], v[72:75], v[152:155], v[160:175]
    v_mfma_f32_32x32x16_bf16 v[176:191], v[76:79], v[152:155], v[176:191]
    v_mfma_f32_32x32x16_bf16 v[160:175], v[80:83], v[156:159], v[160:175]
    v_mfma_f32_32x32x16_bf16 v[176:191], v[84:87], v[156:159], v[176:191]
    s_cmp_eq_u32 s69, 0
    s_cbranch_scc1 L_nx97
    v_mfma_f32_32x32x16_bf16 v[192:207], v[104:107], v[140:143], v[192:207]
    v_mfma_f32_32x32x16_bf16 v[192:207], v[108:111], v[144:147], v[192:207]
    v_mfma_f32_32x32x16_bf16 v[192:207], v[112:115], v[148:151], v[192:207]
    v_mfma_f32_32x32x16_bf16 v[192:207], v[116:119], v[152:155], v[192:207]
    v_mfma_f32_32x32x16_bf16 v[192:207], v[120:123], v[156:159], v[192:207]
L_nx97:
    s_waitcnt lgkmcnt(0)
    v_readfirstlane_b32 s48, v6
    s_cmp_ge_u32 s48, 8
    s_cbranch_scc1 L_wbok
L_lw98:
    ds_read_b32 v6, v246 offset:52
    s_waitcnt lgkmcnt(0)
    v_readfirstlane_b32 s48, v6
    s_cmp_ge_u32 s48, 8
    s_cbranch_scc1 L_lwd99
    s_sub_u32 s76, s76, 1
    s_cbranch_scc0 L_lw98
    s_endpgm
L_lwd99:
L_wbok:
    v_add_u32 v7, 28672, v253
    v_add_u32 v253, 83968, v253
    v_lshrrev_b32 v2, 2, v0
    s_lshl_b32 s48, s44, 4
    v_add_u32 v2, s48, v2
    v_and_b32 v3, 3, v0
    v_mul_u32_u24 v5, 2304, v2
    v_lshl_add_u32 v5, v3, 4, v5
    v_mul_u32_u24 v3, 1088, v3
    v_lshl_add_u32 v4, v2, 4, v3
    v_add_u32 v4, 65536, v4
    ds_write_b128 v252, v[160:163] offset:0
    ds_write_b128 v252, v[164:167] offset:1088
    ds_write_b128 v252, v[168:171] offset:2176
    ds_write_b128 v252, v[172:175] offset:3264
    ds_write_b128 v252, v[176:179] offset:4352
    ds_write_b128 v252, v[180:183] offset:5440
    ds_write_b128 v252, v[184:187] offset:6528
    ds_write_b128 v252, v[188:191] offset:7616
    s_cmp_eq_u32 s69, 0
    s_cbranch_scc1 L_fnx
    s_lshr_b32 s48, s44, 1
    s_mul_i32 s48, s48, 4352
    s_add_u32 s48, s48, 65536
    v_add_u32 v1, s48, v244
    ds_write_b128 v1, v[192:195] offset:0
    ds_write_b128 v1, v[196:199] offset:1088
    ds_write_b128 v1, v[200:203] offset:2176
    ds_write_b128 v1, v[204:207] offset:3264
L_fnx:
    s_waitcnt lgkmcnt(0)
    s_barrier
    ds_read_b128 v[16:19], v253 offset:0
    ds_read_b128 v[20:23], v253 offset:512
    ds_read_b128 v[24:27], v253 offset:17408
    ds_read_b128 v[28:31], v253 offset:17920
    ds_read_b128 v[32:35], v253 offset:34816
    ds_read_b128 v[36:39], v253 offset:35328
    ds_read_b128 v[40:43], v253 offset:52224
    ds_read_b128 v[44:47], v253 offset:52736
    ds_read_b128 v[48:51], v7 offset:0
    ds_read_b128 v[52:55], v7 offset:512
    ds_read_b128 v[56:59], v7 offset:17408
    ds_read_b128 v[60:63], v7 offset:17920
    s_cmp_gt_u32 s44, 1
    s_cbranch_scc1 L_fin_a
    s_mul_i32 s48, s71, 147456
    s_and_b32 s49, s72, 1
    s_mul_i32 s49, s49, 73728
    s_add_u32 s48, s48, s49
    s_and_b32 s49, s72, 2
    s_lshl_b32 s49, s49, 5
    s_add_u32 s48, s48, s49
    s_add_u32 s48, s48, 1024
    s_bitcmp1_b32 s72, 2
    s_cbranch_scc0 L_fin_x
    s_add_u32 s48, s48, 1152
    ds_read_b128 v[64:67], v4 offset:0
    ds_read_b128 v[68:71], v4 offset:512
    ds_read_b128 v[72:75], v4 offset:4352
    ds_read_b128 v[76:79], v4 offset:4864
    ds_read_b128 v[80:83], v4 offset:8704
    ds_read_b128 v[84:87], v4 offset:9216
    ds_read_b128 v[88:91], v4 offset:13056
    ds_read_b128 v[92:95], v4 offset:13568
    s_waitcnt lgkmcnt(0)
    v_pk_add_f32 v[64:65], v[64:65], v[72:73]
    v_pk_add_f32 v[66:67], v[66:67], v[74:75]
    v_pk_add_f32 v[68:69], v[68:69], v[76:77]
    v_pk_add_f32 v[70:71], v[70:71], v[78:79]
    v_pk_add_f32 v[64:65], v[64:65], v[80:81]
    v_pk_add_f32 v[66:67], v[66:67], v[82:83]
    v_pk_add_f32 v[68:69], v[68:69], v[84:85]
    v_pk_add_f32 v[70:71], v[70:71], v[86:87]
    v_pk_add_f32 v[64:65], v[64:65], v[88:89]
    v_pk_add_f32 v[66:67], v[66:67], v[90:91]
    v_pk_add_f32 v[68:69], v[68:69], v[92:93]
    v_pk_add_f32 v[70:71], v[70:71], v[94:95]
    v_cvt_pk_bf16_f32 v64, v64, v65
    v_cvt_pk_bf16_f32 v65, v66, v67
    v_cvt_pk_bf16_f32 v66, v68, v69
    v_cvt_pk_bf16_f32 v67, v70, v71
    buffer_store_dwordx4 v[64:67], v5, s[32:35], s48 offen
    s_branch L_fin_a
L_fin_x:
    ds_read_b128 v[64:67], v4 offset:0
    ds_read_b128 v[68:71], v4 offset:512
    ds_read_b128 v[72:75], v4 offset:4352
    ds_read_b128 v[76:79], v4 offset:4864
    s_waitcnt lgkmcnt(0)
    v_pk_add_f32 v[64:65], v[64:65], v[72:73]
    v_pk_add_f32 v[66:67], v[66:67], v[74:75]
    v_pk_add_f32 v[68:69], v[68:69], v[76:77]
    v_pk_add_f32 v[70:71], v[70:71], v[78:79]
    v_cvt_pk_bf16_f32 v64, v64, v65
    v_cvt_pk_bf16_f32 v65, v66, v67
    v_cvt_pk_bf16_f32 v66, v68, v69
    v_cvt_pk_bf16_f32 v67, v70, v71
    buffer_store_dwordx4 v[64:67], v5, s[32:35], s48 offen
L_fin_a:
    s_waitcnt lgkmcnt(4)
    v_pk_add_f32 v[16:17], v[16:17], v[24:25]
    v_pk_add_f32 v[18:19], v[18:19], v[26:27]
    v_pk_add_f32 v[20:21], v[20:21], v[28:29]
    v_pk_add_f32 v[22:23], v[22:23], v[30:31]
    v_pk_add_f32 v[16:17], v[16:17], v[32:33]
    v_pk_add_f32 v[18:19], v[18:19], v[34:35]
    v_pk_add_f32 v[20:21], v[20:21], v[36:37]
    v_pk_add_f32 v[22:23], v[22:23], v[38:39]
    v_pk_add_f32 v[16:17], v[16:17], v[40:41]
    v_pk_add_f32 v[18:19], v[18:19], v[42:43]
    v_pk_add_f32 v[20:21], v[20:21], v[44:45]
    v_pk_add_f32 v[22:23], v[22:23], v[46:47]
    v_cvt_pk_bf16_f32 v16, v16, v17
    v_cvt_pk_bf16_f32 v17, v18, v19
    v_cvt_pk_bf16_f32 v18, v20, v21
    v_cvt_pk_bf16_f32 v19, v22, v23
    buffer_store_dwordx4 v[16:19], v255, s[32:35], s101 offen
    s_waitcnt lgkmcnt(0)
    v_pk_add_f32 v[48:49], v[48:49], v[56:57]
    v_pk_add_f32 v[50:51], v[50:51], v[58:59]
    v_pk_add_f32 v[52:53], v[52:53], v[60:61]
    v_pk_add_f32 v[54:55], v[54:55], v[62:63]
    v_cvt_pk_bf16_f32 v48, v48, v49
    v_cvt_pk_bf16_f32 v49, v50, v51
    v_cvt_pk_bf16_f32 v50, v52, v53
    v_cvt_pk_bf16_f32 v51, v54, v55
    buffer_store_dwordx4 v[48:51], v255, s[32:35], s100 offen
    s_endpgm
L_gNs:
    s_cmp_eq_u32 s53, 1
    s_cbranch_scc1 L_gNt
    s_lshl_b32 s3, s96, 12
    s_add_u32 m0, s3, 0
    s_add_u32 vcc_lo, s98, 384
    s_add_u32 vcc_hi, s99, 663552
    buffer_load_dwordx4 v228, s[12:15], vcc_lo offen offset:0 lds
    buffer_load_dwordx4 v229, s[12:15], vcc_lo offen offset:1024 lds
    buffer_load_dwordx4 v230, s[12:15], vcc_lo offen offset:2048 lds
    buffer_load_dwordx4 v231, s[12:15], vcc_lo offen offset:3072 lds
    s_add_u32 m0, s3, 16384
    s_nop 0
    buffer_load_dwordx4 v232, s[16:19], vcc_hi offen offset:0 lds
    buffer_load_dwordx4 v233, s[16:19], vcc_hi offen offset:1024 lds
    buffer_load_dwordx4 v234, s[16:19], vcc_hi offen offset:2048 lds
    buffer_load_dwordx4 v235, s[16:19], vcc_hi offen offset:3072 lds
    s_mov_b32 s53, 1
    s_branch L_gNb
L_gNt:
    s_lshl_b32 s3, s96, 12
    s_add_u32 m0, s3, 32768
    s_add_u32 vcc_lo, s98, 512
    s_add_u32 vcc_hi, s99, 884736
    buffer_load_dwordx4 v228, s[12:15], vcc_lo offen offset:0 lds
    buffer_load_dwordx4 v229, s[12:15], vcc_lo offen offset:1024 lds
    buffer_load_dwordx4 v230, s[12:15], vcc_lo offen offset:2048 lds
    buffer_load_dwordx4 v231, s[12:15], vcc_lo offen offset:3072 lds
    s_add_u32 m0, s3, 49152
    s_nop 0
    buffer_load_dwordx4 v232, s[16:19], vcc_hi offen offset:0 lds
    buffer_load_dwordx4 v233, s[16:19], vcc_hi offen offset:1024 lds
    buffer_load_dwordx4 v234, s[16:19], vcc_hi offen offset:2048 lds
    buffer_load_dwordx4 v235, s[16:19], vcc_hi offen offset:3072 lds
    s_mov_b32 s53, 0
    s_branch L_gNb
L_gSs:
    s_cmp_eq_u32 s53, 1
    s_cbranch_scc1 L_gSt
    s_lshl_b32 s3, s96, 12
    s_add_u32 m0, s3, 0
    s_add_u32 vcc_lo, s98, 384
    s_add_u32 vcc_hi, s99, 663552
    buffer_load_dwordx4 v228, s[12:15], vcc_lo offen offset:0 lds
    buffer_load_dwordx4 v229, s[12:15], vcc_lo offen offset:1024 lds
    buffer_load_dwordx4 v230, s[12:15], vcc_lo offen offset:2048 lds
    buffer_load_dwordx4 v231, s[12:15], vcc_lo offen offset:3072 lds
    s_add_u32 m0, s3, 16384
    s_nop 0
    buffer_load_dwordx4 v232, s[16:19], vcc_hi offen offset:0 lds
    buffer_load_dwordx4 v233, s[16:19], vcc_hi offen offset:1024 lds
    buffer_load_dwordx4 v234, s[16:19], vcc_hi offen offset:2048 lds
    buffer_load_dwordx4 v235, s[16:19], vcc_hi offen offset:3072 lds
    s_mov_b32 s53, 1
    s_branch L_gSb
L_gSt:
    s_lshl_b32 s3, s96, 12
    s_add_u32 m0, s3, 32768
    s_add_u32 vcc_lo, s98, 512
    s_add_u32 vcc_hi, s99, 884736
    buffer_load_dwordx4 v228, s[12:15], vcc_lo offen offset:0 lds
    buffer_load_dwordx4 v229, s[12:15], vcc_lo offen offset:1024 lds
    buffer_load_dwordx4 v230, s[12:15], vcc_lo offen offset:2048 lds
    buffer_load_dwordx4 v231, s[12:15], vcc_lo offen offset:3072 lds
    s_add_u32 m0, s3, 49152
    s_nop 0
    buffer_load_dwordx4 v232, s[16:19], vcc_hi offen offset:0 lds
    buffer_load_dwordx4 v233, s[16:19], vcc_hi offen offset:1024 lds
    buffer_load_dwordx4 v234, s[16:19], vcc_hi offen offset:2048 lds
    buffer_load_dwordx4 v235, s[16:19], vcc_hi offen offset:3072 lds
    s_mov_b32 s53, 0
    s_branch L_gSb
L_smx36:
    v_max3_f32 v2, v80, v81, v82
    v_max3_f32 v4, -v80, -v81, -v82
    v_max3_f32 v2, v2, v83, v84
    v_max3_f32 v4, v4, -v83, -v84
    v_max3_f32 v2, v2, v85, v86
    v_max3_f32 v4, v4, -v85, -v86
    v_max3_f32 v2, v2, v87, v88
    v_max3_f32 v4, v4, -v87, -v88
    s_nop 1
    v_permlane32_swap_b32 v2, v4
    v_max_f32 v2, v2, v4
    v_mov_b32 v4, v2
    s_nop 1
    v_permlane32_swap_b32 v2, v4
    v_sub_f32 v144, v80, v2
    v_sub_f32 v156, -v80, v4
    v_sub_f32 v145, v81, v2
    v_sub_f32 v157, -v81, v4
    v_sub_f32 v146, v82, v2
    v_sub_f32 v158, -v82, v4
    v_sub_f32 v147, v83, v2
    v_sub_f32 v159, -v83, v4
    v_sub_f32 v148, v84, v2
    v_sub_f32 v160, -v84, v4
    v_sub_f32 v149, v85, v2
    v_sub_f32 v161, -v85, v4
    v_sub_f32 v150, v86, v2
    v_sub_f32 v162, -v86, v4
    v_sub_f32 v151, v87, v2
    v_sub_f32 v163, -v87, v4
    v_sub_f32 v152, v88, v2
    v_sub_f32 v164, -v88, v4
    v_mul_f32 v144, s50, v144
    v_mul_f32 v145, s50, v145
    v_mul_f32 v146, s50, v146
    v_mul_f32 v147, s50, v147
    v_mul_f32 v148, s50, v148
    v_mul_f32 v149, s50, v149
    v_mul_f32 v150, s50, v150
    v_mul_f32 v151, s50, v151
    v_mul_f32 v152, s50, v152
    v_mul_f32 v156, s50, v156
    v_mul_f32 v157, s50, v157
    v_mul_f32 v158, s50, v158
    v_mul_f32 v159, s50, v159
    v_mul_f32 v160, s50, v160
    v_mul_f32 v161, s50, v161
    v_mul_f32 v162, s50, v162
    v_mul_f32 v163, s50, v163
    v_mul_f32 v164, s50, v164
    v_exp_f32 v144, v144
    v_exp_f32 v145, v145
    v_exp_f32 v146, v146
    v_exp_f32 v147, v147
    v_exp_f32 v148, v148
    v_exp_f32 v149, v149
    v_exp_f32 v150, v150
    v_exp_f32 v151, v151
    v_exp_f32 v152, v152
    v_exp_f32 v156, v156
    v_exp_f32 v157, v157
    v_exp_f32 v158, v158
    v_exp_f32 v159, v159
    v_exp_f32 v160, v160
    v_exp_f32 v161, v161
    v_exp_f32 v162, v162
    v_exp_f32 v163, v163
    v_exp_f32 v164, v164
    v_pk_add_f32 v[2:3], v[144:145], v[146:147]
    v_pk_add_f32 v[4:5], v[156:157], v[158:159]
    v_pk_add_f32 v[2:3], v[2:3], v[148:149]
    v_pk_add_f32 v[4:5], v[4:5], v[160:161]
    v_pk_add_f32 v[2:3], v[2:3], v[150:151]
    v_pk_add_f32 v[4:5], v[4:5], v[162:163]
    v_add_f32 v2, v2, v152
    v_add_f32 v4, v4, v164
    v_add_f32 v2, v2, v3
    v_add_f32 v4, v4, v5
    s_nop 1
    v_permlane32_swap_b32 v2, v4
    v_add_f32 v2, v2, v4
    s_branch L_smb37
L_smx42:
    v_max3_f32 v2, v96, v97, v98
    v_max3_f32 v4, -v96, -v97, -v98
    v_max3_f32 v2, v2, v99, v100
    v_max3_f32 v4, v4, -v99, -v100
    v_max3_f32 v2, v2, v101, v102
    v_max3_f32 v4, v4, -v101, -v102
    v_max3_f32 v2, v2, v103, v104
    v_max3_f32 v4, v4, -v103, -v104
    s_nop 1
    v_permlane32_swap_b32 v2, v4
    v_max_f32 v2, v2, v4
    v_mov_b32 v4, v2
    s_nop 1
    v_permlane32_swap_b32 v2, v4
    v_sub_f32 v144, v96, v2
    v_sub_f32 v156, -v96, v4
    v_sub_f32 v145, v97, v2
    v_sub_f32 v157, -v97, v4
    v_sub_f32 v146, v98, v2
    v_sub_f32 v158, -v98, v4
    v_sub_f32 v147, v99, v2
    v_sub_f32 v159, -v99, v4
    v_sub_f32 v148, v100, v2
    v_sub_f32 v160, -v100, v4
    v_sub_f32 v149, v101, v2
    v_sub_f32 v161, -v101, v4
    v_sub_f32 v150, v102, v2
    v_sub_f32 v162, -v102, v4
    v_sub_f32 v151, v103, v2
    v_sub_f32 v163, -v103, v4
    v_sub_f32 v152, v104, v2
    v_sub_f32 v164, -v104, v4
    v_mul_f32 v144, s50, v144
    v_mul_f32 v145, s50, v145
    v_mul_f32 v146, s50, v146
    v_mul_f32 v147, s50, v147
    v_mul_f32 v148, s50, v148
    v_mul_f32 v149, s50, v149
    v_mul_f32 v150, s50, v150
    v_mul_f32 v151, s50, v151
    v_mul_f32 v152, s50, v152
    v_mul_f32 v156, s50, v156
    v_mul_f32 v157, s50, v157
    v_mul_f32 v158, s50, v158
    v_mul_f32 v159, s50, v159
    v_mul_f32 v160, s50, v160
    v_mul_f32 v161, s50, v161
    v_mul_f32 v162, s50, v162
    v_mul_f32 v163, s50, v163
    v_mul_f32 v164, s50, v164
    v_exp_f32 v144, v144
    v_exp_f32 v145, v145
    v_exp_f32 v146, v146
    v_exp_f32 v147, v147
    v_exp_f32 v148, v148
    v_exp_f32 v149, v149
    v_exp_f32 v150, v150
    v_exp_f32 v151, v151
    v_exp_f32 v152, v152
    v_exp_f32 v156, v156
    v_exp_f32 v157, v157
    v_exp_f32 v158, v158
    v_exp_f32 v159, v159
    v_exp_f32 v160, v160
    v_exp_f32 v161, v161
    v_exp_f32 v162, v162
    v_exp_f32 v163, v163
    v_exp_f32 v164, v164
    v_pk_add_f32 v[2:3], v[144:145], v[146:147]
    v_pk_add_f32 v[4:5], v[156:157], v[158:159]
    v_pk_add_f32 v[2:3], v[2:3], v[148:149]
    v_pk_add_f32 v[4:5], v[4:5], v[160:161]
    v_pk_add_f32 v[2:3], v[2:3], v[150:151]
    v_pk_add_f32 v[4:5], v[4:5], v[162:163]
    v_add_f32 v2, v2, v152
    v_add_f32 v4, v4, v164
    v_add_f32 v2, v2, v3
    v_add_f32 v4, v4, v5
    s_nop 1
    v_permlane32_swap_b32 v2, v4
    v_add_f32 v2, v2, v4
    s_branch L_smb43
L_smx53:
    v_max3_f32 v2, v112, v113, v114
    v_max3_f32 v4, -v112, -v113, -v114
    v_max3_f32 v2, v2, v115, v116
    v_max3_f32 v4, v4, -v115, -v116
    v_max3_f32 v2, v2, v117, v118
    v_max3_f32 v4, v4, -v117, -v118
    v_max3_f32 v2, v2, v119, v120
    v_max3_f32 v4, v4, -v119, -v120
    s_nop 1
    v_permlane32_swap_b32 v2, v4
    v_max_f32 v2, v2, v4
    v_mov_b32 v4, v2
    s_nop 1
    v_permlane32_swap_b32 v2, v4
    v_sub_f32 v144, v112, v2
    v_sub_f32 v156, -v112, v4
    v_sub_f32 v145, v113, v2
    v_sub_f32 v157, -v113, v4
    v_sub_f32 v146, v114, v2
    v_sub_f32 v158, -v114, v4
    v_sub_f32 v147, v115, v2
    v_sub_f32 v159, -v115, v4
    v_sub_f32 v148, v116, v2
    v_sub_f32 v160, -v116, v4
    v_sub_f32 v149, v117, v2
    v_sub_f32 v161, -v117, v4
    v_sub_f32 v150, v118, v2
    v_sub_f32 v162, -v118, v4
    v_sub_f32 v151, v119, v2
    v_sub_f32 v163, -v119, v4
    v_sub_f32 v152, v120, v2
    v_sub_f32 v164, -v120, v4
    v_mul_f32 v144, s50, v144
    v_mul_f32 v145, s50, v145
    v_mul_f32 v146, s50, v146
    v_mul_f32 v147, s50, v147
    v_mul_f32 v148, s50, v148
    v_mul_f32 v149, s50, v149
    v_mul_f32 v150, s50, v150
    v_mul_f32 v151, s50, v151
    v_mul_f32 v152, s50, v152
    v_mul_f32 v156, s50, v156
    v_mul_f32 v157, s50, v157
    v_mul_f32 v158, s50, v158
    v_mul_f32 v159, s50, v159
    v_mul_f32 v160, s50, v160
    v_mul_f32 v161, s50, v161
    v_mul_f32 v162, s50, v162
    v_mul_f32 v163, s50, v163
    v_mul_f32 v164, s50, v164
    v_exp_f32 v144, v144
    v_exp_f32 v145, v145
    v_exp_f32 v146, v146
    v_exp_f32 v147, v147
    v_exp_f32 v148, v148
    v_exp_f32 v149, v149
    v_exp_f32 v150, v150
    v_exp_f32 v151, v151
    v_exp_f32 v152, v152
    v_exp_f32 v156, v156
    v_exp_f32 v157, v157
    v_exp_f32 v158, v158
    v_exp_f32 v159, v159
    v_exp_f32 v160, v160
    v_exp_f32 v161, v161
    v_exp_f32 v162, v162
    v_exp_f32 v163, v163
    v_exp_f32 v164, v164
    v_pk_add_f32 v[2:3], v[144:145], v[146:147]
    v_pk_add_f32 v[4:5], v[156:157], v[158:159]
    v_pk_add_f32 v[2:3], v[2:3], v[148:149]
    v_pk_add_f32 v[4:5], v[4:5], v[160:161]
    v_pk_add_f32 v[2:3], v[2:3], v[150:151]
    v_pk_add_f32 v[4:5], v[4:5], v[162:163]
    v_add_f32 v2, v2, v152
    v_add_f32 v4, v4, v164
    v_add_f32 v2, v2, v3
    v_add_f32 v4, v4, v5
    s_nop 1
    v_permlane32_swap_b32 v2, v4
    v_add_f32 v2, v2, v4
    s_branch L_smb54
L_smx59:
    v_max3_f32 v2, v128, v129, v130
    v_max3_f32 v4, -v128, -v129, -v130
    v_max3_f32 v2, v2, v131, v132
    v_max3_f32 v4, v4, -v131, -v132
    v_max3_f32 v2, v2, v133, v134
    v_max3_f32 v4, v4, -v133, -v134
    v_max3_f32 v2, v2, v135, v136
    v_max3_f32 v4, v4, -v135, -v136
    s_nop 1
    v_permlane32_swap_b32 v2, v4
    v_max_f32 v2, v2, v4
    v_mov_b32 v4, v2
    s_nop 1
    v_permlane32_swap_b32 v2, v4
    v_sub_f32 v144, v128, v2
    v_sub_f32 v156, -v128, v4
    v_sub_f32 v145, v129, v2
    v_sub_f32 v157, -v129, v4
    v_sub_f32 v146, v130, v2
    v_sub_f32 v158, -v130, v4
    v_sub_f32 v147, v131, v2
    v_sub_f32 v159, -v131, v4
    v_sub_f32 v148, v132, v2
    v_sub_f32 v160, -v132, v4
    v_sub_f32 v149, v133, v2
    v_sub_f32 v161, -v133, v4
    v_sub_f32 v150, v134, v2
    v_sub_f32 v162, -v134, v4
    v_sub_f32 v151, v135, v2
    v_sub_f32 v163, -v135, v4
    v_sub_f32 v152, v136, v2
    v_sub_f32 v164, -v136, v4
    v_mul_f32 v144, s50, v144
    v_mul_f32 v145, s50, v145
    v_mul_f32 v146, s50, v146
    v_mul_f32 v147, s50, v147
    v_mul_f32 v148, s50, v148
    v_mul_f32 v149, s50, v149
    v_mul_f32 v150, s50, v150
    v_mul_f32 v151, s50, v151
    v_mul_f32 v152, s50, v152
    v_mul_f32 v156, s50, v156
    v_mul_f32 v157, s50, v157
    v_mul_f32 v158, s50, v158
    v_mul_f32 v159, s50, v159
    v_mul_f32 v160, s50, v160
    v_mul_f32 v161, s50, v161
    v_mul_f32 v162, s50, v162
    v_mul_f32 v163, s50, v163
    v_mul_f32 v164, s50, v164
    v_exp_f32 v144, v144
    v_exp_f32 v145, v145
    v_exp_f32 v146, v146
    v_exp_f32 v147, v147
    v_exp_f32 v148, v148
    v_exp_f32 v149, v149
    v_exp_f32 v150, v150
    v_exp_f32 v151, v151
    v_exp_f32 v152, v152
    v_exp_f32 v156, v156
    v_exp_f32 v157, v157
    v_exp_f32 v158, v158
    v_exp_f32 v159, v159
    v_exp_f32 v160, v160
    v_exp_f32 v161, v161
    v_exp_f32 v162, v162
    v_exp_f32 v163, v163
    v_exp_f32 v164, v164
    v_pk_add_f32 v[2:3], v[144:145], v[146:147]
    v_pk_add_f32 v[4:5], v[156:157], v[158:159]
    v_pk_add_f32 v[2:3], v[2:3], v[148:149]
    v_pk_add_f32 v[4:5], v[4:5], v[160:161]
    v_pk_add_f32 v[2:3], v[2:3], v[150:151]
    v_pk_add_f32 v[4:5], v[4:5], v[162:163]
    v_add_f32 v2, v2, v152
    v_add_f32 v4, v4, v164
    v_add_f32 v2, v2, v3
    v_add_f32 v4, v4, v5
    s_nop 1
    v_permlane32_swap_b32 v2, v4
    v_add_f32 v2, v2, v4
    s_branch L_smb60
L_end:
    s_endpgm
.section .rodata,"a"
.p2align 6
.amdhsa_kernel concat_heads__linear_kernel_hedgehog__softmax_full_mha__prompt_kernel
  .amdhsa_next_free_vgpr 256
  .amdhsa_next_free_sgpr 102
  .amdhsa_accum_offset 256
  .amdhsa_group_segment_fixed_size 0
  .amdhsa_kernarg_size 80
  .amdhsa_user_sgpr_count 2
  .amdhsa_user_sgpr_kernarg_segment_ptr 1
  .amdhsa_system_sgpr_workgroup_id_x 1
.end_amdhsa_kernel
```
